```python
import torch

def _softmax(x, axis=-1):
    return torch.softmax(x, dim=axis)
def _gelu(x):
    return torch.nn.functional.gelu(x, approximate="tanh")
def _silu(x):
    return torch.nn.functional.silu(x)
def _sigmoid(x):
    return torch.sigmoid(x)
def _layernorm(x, axis=-1, eps=1e-5):
    m = x.mean(dim=axis, keepdim=True)
    v = x.var(dim=axis, keepdim=True, unbiased=False)
    return (x - m) / torch.sqrt(v + eps)
def _scatter_add(tgt, idx, src, axis=0):
    return tgt.clone().index_add_(axis, idx, src)
def _segment_sum(src, seg, n):
    out = torch.zeros((n,) + src.shape[1:], dtype=src.dtype)
    return out.index_add_(0, seg, src)
def _pad(x, pw):
    flat = tuple(v for pair in reversed(pw) for v in pair)
    return torch.nn.functional.pad(x, flat)

kernel_name = 'gated_mix__gqa_block_cached__gqa_block_cached__decode'

def setup_inputs():

    _w = (lambda a: (lambda t: t.to(torch.bfloat16) if t.is_floating_point() else t)(torch.as_tensor(a)))
    def _A_setup():
        B, Sq, D = 1, 1, 640
        Hq, Hkv, Sk, Dh = 32, 32, 16384, 128
        assert Hq % Hkv == 0, (Hq, Hkv)
        return {
            "x": _w((lambda *s: torch.randn(*s, dtype=torch.bfloat16) * 0.05)(B, Sq, D)),
            "k_cache": _w((lambda *s: torch.randn(*s, dtype=torch.bfloat16) * 3.2)(B, Hkv, Sk, Dh)),
            "v_cache": _w((lambda *s: torch.randn(*s, dtype=torch.bfloat16) * 0.05)(B, Hkv, Sk, Dh)),
            "wq": _w((lambda *s: torch.randn(*s, dtype=torch.bfloat16) * 3.2)(D, Hq * Dh) * (D ** -0.5)),
            "wo": _w((lambda *s: torch.randn(*s, dtype=torch.bfloat16) * 0.05)(Hq * Dh, D) * ((Hq * Dh) ** -0.5)),
        }
    _A_in = _A_setup()

    def _B_setup():
        B, Sq, D = 1, 1, 640
        Hq, Hkv, Sk, Dh = 32, 32, 16384, 128
        assert Hq % Hkv == 0, (Hq, Hkv)
        return {
            "x": _w((lambda *s: torch.randn(*s, dtype=torch.bfloat16) * 0.05)(B, Sq, D)),
            "k_cache": _w((lambda *s: torch.randn(*s, dtype=torch.bfloat16) * 3.2)(B, Hkv, Sk, Dh)),
            "v_cache": _w((lambda *s: torch.randn(*s, dtype=torch.bfloat16) * 0.05)(B, Hkv, Sk, Dh)),
            "wq": _w((lambda *s: torch.randn(*s, dtype=torch.bfloat16) * 3.2)(D, Hq * Dh) * (D ** -0.5)),
            "wo": _w((lambda *s: torch.randn(*s, dtype=torch.bfloat16) * 0.05)(Hq * Dh, D) * ((Hq * Dh) ** -0.5)),
        }
    _B_in = _B_setup()

    return {
        "A_x": _A_in["x"],
        "A_k_cache": _A_in["k_cache"],
        "A_v_cache": _A_in["v_cache"],
        "A_wq": _A_in["wq"],
        "A_wo": _A_in["wo"],
        "B_x": _B_in["x"],
        "B_k_cache": _B_in["k_cache"],
        "B_v_cache": _B_in["v_cache"],
        "B_wq": _B_in["wq"],
        "B_wo": _B_in["wo"],
        "gate_w": _w((lambda *s: torch.randn(*s, dtype=torch.bfloat16) * 0.05)(640) * 16.0),
    }

def reference(A_x, A_k_cache, A_v_cache, A_wq, A_wo, B_x, B_k_cache, B_v_cache, B_wq, B_wo, gate_w):
    def _A_ref(x, k_cache, v_cache, wq, wo):
        B, Sq, D = x.shape
        Hq, Dh = 32, 128
        Hkv = k_cache.shape[1]
        rep = Hq // Hkv
        q = (lambda x, *d: x.permute(*d))((x @ wq).reshape(B, Sq, Hq, Dh), 0, 2, 1, 3)
        k = (lambda x, n, axis: torch.repeat_interleave(x, n, dim=axis))(k_cache, rep, axis=1)
        v = (lambda x, n, axis: torch.repeat_interleave(x, n, dim=axis))(v_cache, rep, axis=1)
        scores = torch.einsum("bhqd,bhkd->bhqk", q, k) * (Dh ** -0.5)
        p = _softmax(scores, axis=-1)
        o = torch.einsum("bhqk,bhkd->bhqd", p, v)
        return (lambda x, *d: x.permute(*d))(o, 0, 2, 1, 3).reshape(B, Sq, Hq * Dh) @ wo

    def _B_ref(x, k_cache, v_cache, wq, wo):
        B, Sq, D = x.shape
        Hq, Dh = 32, 128
        Hkv = k_cache.shape[1]
        rep = Hq // Hkv
        q = (lambda x, *d: x.permute(*d))((x @ wq).reshape(B, Sq, Hq, Dh), 0, 2, 1, 3)
        k = (lambda x, n, axis: torch.repeat_interleave(x, n, dim=axis))(k_cache, rep, axis=1)
        v = (lambda x, n, axis: torch.repeat_interleave(x, n, dim=axis))(v_cache, rep, axis=1)
        scores = torch.einsum("bhqd,bhkd->bhqk", q, k) * (Dh ** -0.5)
        p = _softmax(scores, axis=-1)
        o = torch.einsum("bhqk,bhkd->bhqd", p, v)
        return (lambda x, *d: x.permute(*d))(o, 0, 2, 1, 3).reshape(B, Sq, Hq * Dh) @ wo

    x = A_x
    g = _sigmoid((x * gate_w).sum(-1, keepdims=True))
    a = _A_ref(x, A_k_cache, A_v_cache, A_wq, A_wo)
    b = _B_ref(x, B_k_cache, B_v_cache, B_wq, B_wo)
    return g * a + (1 - g) * b
```

```asm
; @launch grid=(256,1,1) block=(256,1,1) lds=156160
.amdgcn_target "amdgcn-amd-amdhsa--gfx950"
.text
.globl gated_mix__gqa_block_cached__gqa_block_cached__decode_kernel
.p2align 8
.type gated_mix__gqa_block_cached__gqa_block_cached__decode_kernel,@function
gated_mix__gqa_block_cached__gqa_block_cached__decode_kernel:
  s_cmp_ge_u32 s2, 256
  s_cbranch_scc1 L_end
  s_load_dwordx8 s[4:11], s[0:1], 8
  s_load_dwordx2 s[40:41], s[0:1], 0
  s_load_dwordx16 s[12:27], s[0:1], 48
  s_getpc_b64 s[82:83]
L_pc:
  v_mul_u32_u24 v126, 48, v0
  v_mov_b32 v127, s83
  v_add_co_u32 v126, vcc, s82, v126
  s_nop 1
  v_addc_co_u32 v127, vcc, 0, v127, vcc
  global_load_dword v63, v[126:127], off
  v_lshrrev_b32 v3, 6, v0
  v_and_b32 v1, 63, v0
  v_readfirstlane_b32 s3, v3
  v_lshrrev_b32 v44, 4, v1
  v_and_b32 v45, 15, v1
  v_lshlrev_b32 v4, 13, v44
  v_lshl_add_u32 v4, v45, 4, v4
  v_lshlrev_b32 v5, 3, v45
  v_lshl_add_u32 v5, v44, 1, v5
  v_lshlrev_b32 v2, 4, v1
  v_lshrrev_b32 v3, 5, v1
  v_mul_u32_u24 v11, 1536, v3
  v_add_u32 v11, v11, v2
  s_and_b32 s62, s2, 7
  s_and_b32 s61, s2, 3
  s_lshr_b32 s76, s2, 3
  s_lshl_b32 s68, s61, 2
  s_add_u32 s68, s68, s3
  s_mul_i32 s69, s68, 80
  s_mul_i32 s70, s68, 327680
  s_lshl_b32 s71, s76, 8
  s_add_u32 s70, s70, s71
  s_movk_i32 s42, 1280
  s_mov_b32 s43, 0x20000
  s_mov_b32 s38, 5242880
  s_mov_b32 s39, 0x20000
  s_andn2_b32 s66, s2, 7
  s_add_u32 s66, s66, s3
  s_lshl_b32 s67, s66, 9
  s_lshl_b32 s73, s76, 2
  s_add_u32 s73, s73, s3
  s_lshl_b32 s73, s73, 8
  s_add_u32 s73, s73, 262144
  s_mov_b32 s46, 557846272
  s_mov_b32 s47, 0x20000
  s_xor_b32 s68, s76, s2
  s_and_b32 s68, s68, 7
  s_cselect_b32 s84, 255, s76
  s_cmp_lt_u32 s84, 20
  s_cselect_b32 s77, s3, 0
  s_cmp_lt_u32 s62, 4
  s_waitcnt lgkmcnt(0)
  s_mov_b64 s[44:45], s[26:27]
  s_cselect_b64 s[36:37], s[8:9], s[16:17]
  buffer_load_dwordx4 v[52:55], v11, s[44:47], s67 offen sc1
  s_cmp_lg_u32 s77, 3
  s_cbranch_scc1 L_nogl
  s_mov_b64 s[56:57], s[20:21]
  s_movk_i32 s58, 1280
  s_mov_b32 s59, 0x20000
  v_lshlrev_b32 v6, 2, v1
  buffer_load_dwordx4 v[104:107], v2, s[40:43], 0 offen
  buffer_load_dword v108, v6, s[40:43], 0 offen offset:1024
  buffer_load_dwordx4 v[112:115], v2, s[56:59], 0 offen
  buffer_load_dword v116, v6, s[56:59], 0 offen offset:1024
L_nogl:
  buffer_load_ushort v47, v5, s[40:43], s69 offen
  buffer_load_dwordx4 v[64:67], v4, s[36:39], s70 offen nt
  s_add_u32 s70, s70, 32768
  buffer_load_dwordx4 v[68:71], v4, s[36:39], s70 offen nt
  s_add_u32 s70, s70, 32768
  buffer_load_dwordx4 v[72:75], v4, s[36:39], s70 offen nt
  s_add_u32 s70, s70, 32768
  buffer_load_dwordx4 v[76:79], v4, s[36:39], s70 offen nt
  s_add_u32 s70, s70, 32768
  buffer_load_dwordx4 v[80:83], v4, s[36:39], s70 offen nt
  s_add_u32 s70, s70, 32768
  buffer_load_dwordx4 v[84:87], v4, s[36:39], s70 offen nt
  s_add_u32 s70, s70, 32768
  buffer_load_dwordx4 v[88:91], v4, s[36:39], s70 offen nt
  s_add_u32 s70, s70, 32768
  buffer_load_dwordx4 v[92:95], v4, s[36:39], s70 offen nt
  s_add_u32 s70, s70, 32768
  buffer_load_dwordx4 v[96:99], v4, s[36:39], s70 offen nt
  s_add_u32 s70, s70, 32768
  buffer_load_dwordx4 v[100:103], v4, s[36:39], s70 offen nt
  s_load_dword s60, s[26:27], s73
  s_mov_b32 s70, s67
  s_cmp_lt_u32 s62, 4
  s_cselect_b64 s[36:37], s[10:11], s[18:19]
  v_and_b32 v3, 7, v1
  v_lshlrev_b32 v209, 4, v3
  v_lshlrev_b32 v208, 3, v44
  v_lshl_add_u32 v208, v3, 7, v208
  s_mul_i32 s10, s2, 1152
  s_add_u32 s10, s10, 524288
  s_lshl_b32 s11, s3, 5
  s_add_u32 s11, s11, s10
  buffer_load_dwordx2 v[196:197], v208, s[44:47], s11 offen sc1
  buffer_load_dwordx2 v[198:199], v209, s[44:47], s10 offen offset:1024 sc1
  s_mov_b64 s[28:29], s[4:5]
  s_mov_b32 s30, 0x8000000
  s_mov_b32 s31, 0x20000
  s_mov_b64 s[32:33], s[4:5]
  s_mov_b32 s34, 0x8000000
  s_mov_b32 s35, 0x20000
  s_lshl_b32 s72, s76, 22
  s_lshl_b32 s69, s3, 12
  s_add_u32 s72, s72, s69
  s_lshl_b32 s18, s62, 14
  s_add_u32 s18, s18, s72
  s_mov_b32 s64, s18
  s_mul_i32 s71, s3, 32768
  s_add_u32 s71, s71, 25088
  v_add_u32 v9, s71, v2
  s_mov_b32 m0, s71
  s_add_u32 s71, s71, 4096
  buffer_load_dwordx4 v2, s[28:31], s64 offen offset:0 nt lds
  buffer_load_dwordx4 v2, s[28:31], s64 offen offset:1024 nt lds
  buffer_load_dwordx4 v2, s[28:31], s64 offen offset:2048 nt lds
  buffer_load_dwordx4 v2, s[28:31], s64 offen offset:3072 nt lds
  v_and_b32 v213, 1, v44
  v_lshlrev_b32 v213, 4, v213
  v_lshrrev_b32 v3, 1, v44
  v_add_u32 v213, v213, v3
  v_mul_u32_u24 v213, 1280, v213
  v_lshl_add_u32 v213, v45, 4, v213
  s_lshl_b32 s16, s76, 7
  s_lshl_b32 s69, s61, 5
  s_add_u32 s16, s16, s69
  s_lshl_b32 s69, s3, 1
  s_add_u32 s16, s16, s69
  s_mul_i32 s16, s16, 1280
  s_add_u32 s17, s16, 10240
  v_and_b32 v3, 1, v45
  v_lshlrev_b32 v3, 4, v3
  v_mov_b32 v4, 0xffff
  v_lshlrev_b32 v3, v3, v4
  v_lshrrev_b32 v4, 1, v45
  v_cmp_eq_u32 vcc, 0, v4
  s_add_u32 s80, s82, L_next-L_pc
  s_addc_u32 s81, s83, 0
  v_cndmask_b32 v12, 0, v3, vcc
  v_cmp_eq_u32 vcc, 1, v4
  s_mul_i32 s8, s66, 1152
  s_mov_b32 s65, 0
  v_cndmask_b32 v13, 0, v3, vcc
  v_cmp_eq_u32 vcc, 2, v4
  s_add_u32 s8, s8, 524288
  s_mov_b32 s66, 11
  v_cndmask_b32 v14, 0, v3, vcc
  v_cmp_eq_u32 vcc, 3, v4
  s_lshl_b32 s69, s3, 9
  s_mov_b32 s75, 1
  v_cndmask_b32 v15, 0, v3, vcc
  v_lshlrev_b32 v5, 7, v44
  v_lshl_add_u32 v46, v45, 4, v5
  v_lshl_add_u32 v5, v45, 2, v5
  v_add_u32 v5, s69, v5
  v_bfe_u32 v210, v1, 2, 3
  s_lshl_b32 s69, s62, 7
  v_lshl_add_u32 v210, v210, 4, s69
  s_lshl_b32 s69, s62, 4
  s_add_u32 s69, s69, 1024
  v_writelane_b32 v210, s69, 1
  v_writelane_b32 v210, s69, 33
  v_lshrrev_b32 v3, 5, v1
  v_mul_u32_u24 v3, 4608, v3
  v_add_u32 v210, v210, v3
  v_lshlrev_b32 v212, 4, v0
  v_lshrrev_b32 v211, 3, v0
  v_lshlrev_b32 v211, 15, v211
  v_and_b32 v3, 127, v212
  v_add_u32 v211, v211, v3
  v_cmp_gt_u32 vcc, 160, v0
  v_bfrev_b32 v3, 1
  s_lshr_b32 s9, s62, 2
  v_cndmask_b32 v211, v3, v211, vcc
  s_lshl_b32 s9, s9, 5
  s_add_u32 s9, s9, s76
  s_lshl_b32 s9, s9, 2
  s_add_u32 s9, s9, s61
  s_lshl_b32 s9, s9, 7
  s_add_u32 s9, s9, 1048576
  v_and_b32 v255, 60, v1
  s_lshl_b32 s69, s3, 11
  s_add_u32 s69, s69, 16896
  v_add_u32 v255, s69, v255
  s_waitcnt vmcnt(16)
  v_lshl_or_b32 v47, v47, 16, v47
  s_cmp_eq_u32 s77, 3
  s_cbranch_scc1 L_gate
L_gret:
  v_and_b32_dpp v24, v47, v12 row_newbcast:0 row_mask:0xf bank_mask:0xf
  v_and_b32_dpp v25, v47, v13 row_newbcast:0 row_mask:0xf bank_mask:0xf
  v_and_b32_dpp v26, v47, v14 row_newbcast:0 row_mask:0xf bank_mask:0xf
  v_and_b32_dpp v27, v47, v15 row_newbcast:0 row_mask:0xf bank_mask:0xf
  v_and_b32_dpp v28, v47, v12 row_newbcast:1 row_mask:0xf bank_mask:0xf
  v_and_b32_dpp v29, v47, v13 row_newbcast:1 row_mask:0xf bank_mask:0xf
  v_and_b32_dpp v30, v47, v14 row_newbcast:1 row_mask:0xf bank_mask:0xf
  v_and_b32_dpp v31, v47, v15 row_newbcast:1 row_mask:0xf bank_mask:0xf
  s_waitcnt vmcnt(15)
  v_mfma_f32_16x16x32_bf16 v[20:23], v[64:67], v[24:27], 0
  v_and_b32_dpp v24, v47, v12 row_newbcast:2 row_mask:0xf bank_mask:0xf
  v_and_b32_dpp v25, v47, v13 row_newbcast:2 row_mask:0xf bank_mask:0xf
  v_and_b32_dpp v26, v47, v14 row_newbcast:2 row_mask:0xf bank_mask:0xf
  v_and_b32_dpp v27, v47, v15 row_newbcast:2 row_mask:0xf bank_mask:0xf
  s_waitcnt vmcnt(14)
  v_mfma_f32_16x16x32_bf16 v[20:23], v[68:71], v[28:31], v[20:23]
  v_and_b32_dpp v28, v47, v12 row_newbcast:3 row_mask:0xf bank_mask:0xf
  v_and_b32_dpp v29, v47, v13 row_newbcast:3 row_mask:0xf bank_mask:0xf
  v_and_b32_dpp v30, v47, v14 row_newbcast:3 row_mask:0xf bank_mask:0xf
  v_and_b32_dpp v31, v47, v15 row_newbcast:3 row_mask:0xf bank_mask:0xf
  s_waitcnt vmcnt(13)
  v_mfma_f32_16x16x32_bf16 v[20:23], v[72:75], v[24:27], v[20:23]
  v_and_b32_dpp v24, v47, v12 row_newbcast:4 row_mask:0xf bank_mask:0xf
  v_and_b32_dpp v25, v47, v13 row_newbcast:4 row_mask:0xf bank_mask:0xf
  v_and_b32_dpp v26, v47, v14 row_newbcast:4 row_mask:0xf bank_mask:0xf
  v_and_b32_dpp v27, v47, v15 row_newbcast:4 row_mask:0xf bank_mask:0xf
  s_waitcnt vmcnt(12)
  v_mfma_f32_16x16x32_bf16 v[20:23], v[76:79], v[28:31], v[20:23]
  v_and_b32_dpp v28, v47, v12 row_newbcast:5 row_mask:0xf bank_mask:0xf
  v_and_b32_dpp v29, v47, v13 row_newbcast:5 row_mask:0xf bank_mask:0xf
  v_and_b32_dpp v30, v47, v14 row_newbcast:5 row_mask:0xf bank_mask:0xf
  v_and_b32_dpp v31, v47, v15 row_newbcast:5 row_mask:0xf bank_mask:0xf
  s_waitcnt vmcnt(11)
  v_mfma_f32_16x16x32_bf16 v[20:23], v[80:83], v[24:27], v[20:23]
  v_and_b32_dpp v24, v47, v12 row_newbcast:6 row_mask:0xf bank_mask:0xf
  v_and_b32_dpp v25, v47, v13 row_newbcast:6 row_mask:0xf bank_mask:0xf
  v_and_b32_dpp v26, v47, v14 row_newbcast:6 row_mask:0xf bank_mask:0xf
  v_and_b32_dpp v27, v47, v15 row_newbcast:6 row_mask:0xf bank_mask:0xf
  s_waitcnt vmcnt(10)
  v_mfma_f32_16x16x32_bf16 v[20:23], v[84:87], v[28:31], v[20:23]
  v_and_b32_dpp v28, v47, v12 row_newbcast:7 row_mask:0xf bank_mask:0xf
  v_and_b32_dpp v29, v47, v13 row_newbcast:7 row_mask:0xf bank_mask:0xf
  v_and_b32_dpp v30, v47, v14 row_newbcast:7 row_mask:0xf bank_mask:0xf
  v_and_b32_dpp v31, v47, v15 row_newbcast:7 row_mask:0xf bank_mask:0xf
  s_waitcnt vmcnt(9)
  v_mfma_f32_16x16x32_bf16 v[20:23], v[88:91], v[24:27], v[20:23]
  v_and_b32_dpp v24, v47, v12 row_newbcast:8 row_mask:0xf bank_mask:0xf
  v_and_b32_dpp v25, v47, v13 row_newbcast:8 row_mask:0xf bank_mask:0xf
  v_and_b32_dpp v26, v47, v14 row_newbcast:8 row_mask:0xf bank_mask:0xf
  v_and_b32_dpp v27, v47, v15 row_newbcast:8 row_mask:0xf bank_mask:0xf
  s_waitcnt vmcnt(8)
  v_mfma_f32_16x16x32_bf16 v[20:23], v[92:95], v[28:31], v[20:23]
  v_and_b32_dpp v28, v47, v12 row_newbcast:9 row_mask:0xf bank_mask:0xf
  v_and_b32_dpp v29, v47, v13 row_newbcast:9 row_mask:0xf bank_mask:0xf
  v_and_b32_dpp v30, v47, v14 row_newbcast:9 row_mask:0xf bank_mask:0xf
  v_and_b32_dpp v31, v47, v15 row_newbcast:9 row_mask:0xf bank_mask:0xf
  s_waitcnt vmcnt(7)
  v_mfma_f32_16x16x32_bf16 v[20:23], v[96:99], v[24:27], v[20:23]
  s_nop 0
  s_waitcnt vmcnt(6)
  v_mfma_f32_16x16x32_bf16 v[20:23], v[100:103], v[28:31], v[20:23]
  v_mov_b32 v3, 0
  ds_write_b32 v3, v3 offset:6152
  s_mov_b64 s[56:57], s[24:25]
  s_movk_i32 s58, 256
  s_mov_b32 s59, 0x20000
  v_and_b32 v8, 0x1f0, v2
  s_mov_b32 exec_lo, 0x00ff00ff
  s_mov_b32 exec_hi, 0x00ff00ff
  ds_write_b32 v5, v20 offset:0
  ds_write_b32 v5, v21 offset:32
  ds_write_b32 v5, v22 offset:64
  ds_write_b32 v5, v23 offset:96
  s_mov_b64 exec, -1
  s_waitcnt vmcnt(4) lgkmcnt(0)
  s_barrier
  s_sub_u32 s85, 224, s60
  s_cmp_lg_u32 s3, s61
  s_cbranch_scc1 L_nopub
  ds_read_b128 v[24:27], v8 offset:0
  ds_read_b128 v[28:31], v8 offset:512
  ds_read_b128 v[32:35], v8 offset:1024
  ds_read_b128 v[36:39], v8 offset:1536
  v_add_u32 v192, 1, v52
  v_add_u32 v193, 1, v53
  v_add_u32 v194, 1, v54
  v_add_u32 v195, 1, v55
  s_waitcnt lgkmcnt(2)
  v_add_f32 v24, v24, v28
  v_add_f32 v25, v25, v29
  v_add_f32 v26, v26, v30
  v_add_f32 v27, v27, v31
  s_waitcnt lgkmcnt(0)
  v_add_f32 v32, v32, v36
  v_add_f32 v33, v33, v37
  v_add_f32 v34, v34, v38
  v_add_f32 v35, v35, v39
  v_add_f32 v24, v24, v32
  v_add_f32 v25, v25, v33
  v_add_f32 v26, v26, v34
  v_add_f32 v27, v27, v35
  v_bfi_b32 v192, 3, v192, v24
  v_bfi_b32 v193, 3, v193, v25
  v_bfi_b32 v194, 3, v194, v26
  v_bfi_b32 v195, 3, v195, v27
  s_cmp_lt_u32 s62, 4
  s_cselect_b32 exec_lo, -1, 0
  s_cselect_b32 exec_hi, 0, -1
  buffer_store_dwordx4 v[192:195], v11, s[44:47], s70 offen sc1
  s_mov_b64 exec, -1
L_nopub:
  buffer_load_dwordx4 v[200:203], v210, s[44:47], s8 offen sc1
  buffer_load_dwordx4 v[204:207], v211, s[44:47], s9 offen sc1
  s_cmp_ge_u32 s84, 20
  s_cbranch_scc1 L_nors
  s_lshl_b32 s48, s84, 15
  s_add_u32 s48, s48, 1048576
  s_add_u32 s49, s48, 4096
  s_add_u32 s50, s49, 4096
  s_add_u32 s51, s50, 4096
  s_add_u32 s52, s51, 4096
  s_add_u32 s53, s52, 4096
  s_add_u32 s54, s53, 4096
  s_add_u32 s55, s54, 4096
  buffer_load_dwordx4 v[216:219], v212, s[44:47], s48 offen sc1
  buffer_load_dwordx4 v[220:223], v212, s[44:47], s49 offen sc1
  buffer_load_dwordx4 v[224:227], v212, s[44:47], s50 offen sc1
  buffer_load_dwordx4 v[228:231], v212, s[44:47], s51 offen sc1
  buffer_load_dwordx4 v[232:235], v212, s[44:47], s52 offen sc1
  buffer_load_dwordx4 v[236:239], v212, s[44:47], s53 offen sc1
  buffer_load_dwordx4 v[240:243], v212, s[44:47], s54 offen sc1
  buffer_load_dwordx4 v[244:247], v212, s[44:47], s55 offen sc1
L_nors:
  s_add_u32 s64, s64, 131072
  s_xor_b32 s64, s64, 16384
  s_mov_b32 m0, s71
  s_add_u32 s71, s71, 4096
  s_waitcnt vmcnt(7)
  buffer_load_dwordx4 v2, s[28:31], s64 offen offset:0 nt lds
  s_waitcnt vmcnt(7)
  buffer_load_dwordx4 v2, s[28:31], s64 offen offset:1024 nt lds
  s_waitcnt vmcnt(7)
  buffer_load_dwordx4 v2, s[28:31], s64 offen offset:2048 nt lds
  s_waitcnt vmcnt(7)
  buffer_load_dwordx4 v2, s[28:31], s64 offen offset:3072 nt lds
  s_add_u32 s64, s64, 131072
  s_xor_b32 s64, s64, 49152
  s_mov_b32 m0, s71
  s_add_u32 s71, s71, 4096
  s_waitcnt vmcnt(7)
  buffer_load_dwordx4 v2, s[28:31], s64 offen offset:0 nt lds
  s_waitcnt vmcnt(7)
  buffer_load_dwordx4 v2, s[28:31], s64 offen offset:1024 nt lds
  s_waitcnt vmcnt(7)
  buffer_load_dwordx4 v2, s[28:31], s64 offen offset:2048 nt lds
  s_waitcnt vmcnt(7)
  buffer_load_dwordx4 v2, s[28:31], s64 offen offset:3072 nt lds
  buffer_load_dwordx4 v[56:59], v11, s[44:47], s70 offen sc1
  s_add_u32 s64, s64, 131072
  s_xor_b32 s64, s64, 16384
  s_mov_b32 m0, s71
  s_add_u32 s71, s71, 4096
  s_waitcnt vmcnt(7)
  buffer_load_dwordx4 v2, s[28:31], s64 offen offset:0 nt lds
  s_waitcnt vmcnt(7)
  buffer_load_dwordx4 v2, s[28:31], s64 offen offset:1024 nt lds
  s_waitcnt vmcnt(7)
  buffer_load_dwordx4 v2, s[28:31], s64 offen offset:2048 nt lds
  s_waitcnt vmcnt(7)
  buffer_load_dwordx4 v2, s[28:31], s64 offen offset:3072 nt lds
  s_add_u32 s64, s64, 131072
  s_xor_b32 s64, s64, 114688
  s_mov_b32 m0, s71
  s_add_u32 s71, s71, 4096
  s_waitcnt vmcnt(7)
  buffer_load_dwordx4 v2, s[28:31], s64 offen offset:0 nt lds
  s_waitcnt vmcnt(7)
  buffer_load_dwordx4 v2, s[28:31], s64 offen offset:1024 nt lds
  buffer_load_dwordx4 v[60:63], v11, s[44:47], s70 offen sc1
  s_waitcnt vmcnt(7)
  v_bitop3_b32 v16, v56, v52, 3 bitop3:0x28
  v_bitop3_b32 v17, v57, v53, 3 bitop3:0x28
  v_bitop3_b32 v18, v58, v54, 3 bitop3:0x28
  v_bitop3_b32 v19, v59, v55, 3 bitop3:0x28
  v_min3_u32 v16, v16, v17, v18
  v_min_u32 v16, v16, v19
  v_cmp_eq_u32 vcc, 0, v16
  s_mov_b32 s74, 0
  s_cbranch_vccnz L_qa
  s_lshl_b32 s69, s3, 9
  v_add_u32 v8, s69, v11
  v_and_b32 v56, -4, v56
  v_and_b32 v57, -4, v57
  v_and_b32 v58, -4, v58
  v_and_b32 v59, -4, v59
  ds_write_b128 v8, v[56:59] offset:2048
  v_mov_b32 v4, 1
  s_mov_b64 exec, 1
  ds_add_u32 v3, v4 offset:6152
  s_mov_b64 exec, -1
  s_mov_b32 s74, -1
L_qa:
  s_waitcnt vmcnt(7)
  buffer_load_dwordx4 v2, s[28:31], s64 offen offset:2048 nt lds
  s_waitcnt vmcnt(7)
  buffer_load_dwordx4 v2, s[28:31], s64 offen offset:3072 nt lds
  s_add_u32 s64, s64, 131072
  s_xor_b32 s64, s64, 16384
  s_mov_b32 m0, s71
  s_add_u32 s71, s71, 4096
  s_waitcnt vmcnt(7)
  buffer_load_dwordx4 v2, s[28:31], s64 offen offset:0 nt lds
  s_waitcnt vmcnt(7)
  buffer_load_dwordx4 v2, s[28:31], s64 offen offset:1024 nt lds
  s_cmp_lg_u32 s74, 0
  s_cbranch_scc0 L_qb
L_qdone:
  s_mov_b32 s74, 0x3fb8aa3b
  v_lshlrev_b32 v8, 5, v45
  v_not_b32 v200, v200
  v_not_b32 v201, v201
  v_not_b32 v202, v202
  v_not_b32 v203, v203
  v_not_b32 v204, v204
  v_not_b32 v205, v205
  v_not_b32 v206, v206
  v_not_b32 v207, v207
  v_mov_b32 v254, v255
  s_waitcnt vmcnt(7)
  buffer_load_dwordx4 v2, s[28:31], s64 offen offset:2048 nt lds
  s_waitcnt vmcnt(7)
  buffer_load_dwordx4 v2, s[28:31], s64 offen offset:3072 nt lds
L_qw:
  ds_read_b32 v4, v3 offset:6152
  s_waitcnt lgkmcnt(0)
  v_readfirstlane_b32 s68, v4
  s_and_b32 s69, s68, 15
  s_cmp_lg_u32 s69, 4
  s_cbranch_scc1 L_qw
  s_cmp_gt_u32 s68, 15
  s_cbranch_scc1 L_late
L_lret:
  ds_read_b128 v[64:67], v8 offset:2048
  ds_read_b128 v[68:71], v8 offset:2064
  ds_read_b128 v[72:75], v8 offset:2560
  ds_read_b128 v[76:79], v8 offset:2576
  ds_read_b128 v[80:83], v8 offset:3072
  ds_read_b128 v[84:87], v8 offset:3088
  ds_read_b128 v[88:91], v8 offset:3584
  ds_read_b128 v[92:95], v8 offset:3600
  v_mov_b32 v5, 0xff800000
  v_add_u32 v215, 512, v255
  s_mov_b32 s19, 6
  s_waitcnt lgkmcnt(0)
  v_add_f32 v64, v64, v72
  v_add_f32 v65, v65, v73
  v_add_f32 v66, v66, v74
  v_add_f32 v67, v67, v75
  v_add_f32 v68, v68, v76
  v_add_f32 v69, v69, v77
  v_add_f32 v70, v70, v78
  v_add_f32 v71, v71, v79
  v_add_f32 v80, v80, v88
  v_add_f32 v81, v81, v89
  v_add_f32 v82, v82, v90
  v_add_f32 v83, v83, v91
  v_add_f32 v84, v84, v92
  v_add_f32 v85, v85, v93
  v_add_f32 v86, v86, v94
  v_add_f32 v87, v87, v95
  v_add_f32 v64, v64, v80
  v_add_f32 v65, v65, v81
  v_add_f32 v66, v66, v82
  v_add_f32 v67, v67, v83
  v_add_f32 v68, v68, v84
  v_add_f32 v69, v69, v85
  v_add_f32 v70, v70, v86
  v_add_f32 v71, v71, v87
  v_cvt_pk_bf16_f32 v40, v64, v65
  v_cvt_pk_bf16_f32 v41, v66, v67
  v_cvt_pk_bf16_f32 v42, v68, v69
  v_cvt_pk_bf16_f32 v43, v70, v71
  s_add_u32 s64, s64, 131072
  s_xor_b32 s64, s64, 49152
  s_mov_b32 m0, s71
  s_add_u32 s71, s71, 4096
  s_waitcnt vmcnt(7)
  buffer_load_dwordx4 v2, s[28:31], s64 offen offset:0 nt lds
  s_waitcnt vmcnt(7)
  buffer_load_dwordx4 v2, s[28:31], s64 offen offset:1024 nt lds
  s_waitcnt vmcnt(7)
  buffer_load_dwordx4 v2, s[28:31], s64 offen offset:2048 nt lds
  s_waitcnt vmcnt(7)
  buffer_load_dwordx4 v2, s[28:31], s64 offen offset:3072 nt lds
  ds_read_b128 v[64:67], v8 offset:4096
  ds_read_b128 v[68:71], v8 offset:4112
  ds_read_b128 v[72:75], v8 offset:4608
  ds_read_b128 v[76:79], v8 offset:4624
  ds_read_b128 v[80:83], v8 offset:5120
  ds_read_b128 v[84:87], v8 offset:5136
  ds_read_b128 v[88:91], v8 offset:5632
  ds_read_b128 v[92:95], v8 offset:5648
  s_waitcnt lgkmcnt(0)
  v_add_f32 v64, v64, v72
  v_add_f32 v65, v65, v73
  v_add_f32 v66, v66, v74
  v_add_f32 v67, v67, v75
  v_add_f32 v68, v68, v76
  v_add_f32 v69, v69, v77
  v_add_f32 v70, v70, v78
  v_add_f32 v71, v71, v79
  v_add_f32 v80, v80, v88
  v_add_f32 v81, v81, v89
  v_add_f32 v82, v82, v90
  v_add_f32 v83, v83, v91
  v_add_f32 v84, v84, v92
  v_add_f32 v85, v85, v93
  v_add_f32 v86, v86, v94
  v_add_f32 v87, v87, v95
  v_add_f32 v64, v64, v80
  v_add_f32 v65, v65, v81
  v_add_f32 v66, v66, v82
  v_add_f32 v67, v67, v83
  v_add_f32 v68, v68, v84
  v_add_f32 v69, v69, v85
  v_add_f32 v70, v70, v86
  v_add_f32 v71, v71, v87
  v_cvt_pk_bf16_f32 v52, v64, v65
  v_cvt_pk_bf16_f32 v53, v66, v67
  v_cvt_pk_bf16_f32 v54, v68, v69
  v_cvt_pk_bf16_f32 v55, v70, v71
  s_add_u32 s64, s64, 131072
  s_xor_b32 s64, s64, 16384
  s_mov_b32 m0, s71
  s_add_u32 s71, s71, 4096
  s_waitcnt vmcnt(7)
  buffer_load_dwordx4 v2, s[28:31], s64 offen offset:0 nt lds
  s_waitcnt vmcnt(7)
  buffer_load_dwordx4 v2, s[28:31], s64 offen offset:1024 nt lds
  s_waitcnt vmcnt(7)
  buffer_load_dwordx4 v2, s[28:31], s64 offen offset:2048 nt lds
  s_waitcnt vmcnt(7)
  buffer_load_dwordx4 v2, s[28:31], s64 offen offset:3072 nt lds
  s_add_u32 s64, s64, 131072
  s_xor_b32 s64, s64, 114688
  s_mov_b32 s63, s64
  s_waitcnt vmcnt(7)
  buffer_load_dwordx4 v[128:131], v2, s[28:31], s64 offen offset:0 nt
  s_waitcnt vmcnt(7)
  buffer_load_dwordx4 v[132:135], v2, s[28:31], s64 offen offset:1024 nt
  s_waitcnt vmcnt(7)
  buffer_load_dwordx4 v[136:139], v2, s[28:31], s64 offen offset:2048 nt
  s_waitcnt vmcnt(7)
  buffer_load_dwordx4 v[140:143], v2, s[28:31], s64 offen offset:3072 nt
  s_add_u32 s64, s64, 131072
  s_xor_b32 s64, s64, 16384
  s_mov_b32 s67, s64
  s_waitcnt vmcnt(7)
  buffer_load_dwordx4 v[144:147], v2, s[28:31], s64 offen offset:0 nt
  s_add_u32 s64, s64, 131072
  s_xor_b32 s64, s64, 16384
  s_mov_b32 s71, 4
  s_cmp_lg_u32 s77, 3
  s_cbranch_scc1 L_noda
  s_lshl_b32 s70, 1, s84
  s_atomic_or s70, s[24:25], 0
L_noda:
  s_mov_b32 s77, 0
L_kl:
  s_waitcnt vmcnt(4)
  buffer_load_dwordx4 v[148:151], v2, s[32:35], s67 offen offset:1024 nt
  v_dot2_f32_bf16 v16, v128, v40, 0
  v_dot2_f32_bf16 v16, v129, v41, v16
  v_dot2_f32_bf16 v16, v130, v42, v16
  v_dot2_f32_bf16 v16, v131, v43, v16
  s_waitcnt vmcnt(4)
  buffer_load_dwordx4 v[152:155], v2, s[32:35], s67 offen offset:2048 nt
  v_dot2_f32_bf16 v17, v132, v40, 0
  v_dot2_f32_bf16 v17, v133, v41, v17
  v_dot2_f32_bf16 v17, v134, v42, v17
  v_dot2_f32_bf16 v17, v135, v43, v17
  s_waitcnt vmcnt(4)
  buffer_load_dwordx4 v[156:159], v2, s[32:35], s67 offen offset:3072 nt
  v_dot2_f32_bf16 v18, v136, v40, 0
  v_dot2_f32_bf16 v18, v137, v41, v18
  v_dot2_f32_bf16 v18, v138, v42, v18
  v_dot2_f32_bf16 v18, v139, v43, v18
  s_swappc_b64 s[78:79], s[80:81]
  s_waitcnt vmcnt(4)
  buffer_load_dwordx4 v[160:163], v2, s[28:31], s63 offen offset:0 nt
  v_dot2_f32_bf16 v19, v140, v40, 0
  v_dot2_f32_bf16 v19, v141, v41, v19
  v_dot2_f32_bf16 v19, v142, v42, v19
  v_dot2_f32_bf16 v19, v143, v43, v19
  v_add_f32_dpp v3, v16, v16 row_ror:8 row_mask:0xf bank_mask:0x3
  v_add_f32_dpp v4, v17, v17 row_ror:8 row_mask:0xf bank_mask:0x3
  s_nop 0
  v_add_f32_dpp v3, v18, v18 row_ror:8 row_mask:0xf bank_mask:0xc
  v_add_f32_dpp v4, v19, v19 row_ror:8 row_mask:0xf bank_mask:0xc
  s_nop 0
  v_add_f32_dpp v3, v3, v3 row_half_mirror row_mask:0xf bank_mask:0x5
  s_nop 1
  v_add_f32_dpp v3, v4, v4 row_half_mirror row_mask:0xf bank_mask:0xa
  s_nop 1
  v_add_f32_dpp v3, v3, v3 quad_perm:[1,0,3,2] row_mask:0xf bank_mask:0xf
  s_nop 1
  v_add_f32_dpp v3, v3, v3 quad_perm:[2,3,0,1] row_mask:0xf bank_mask:0xf
  v_cvt_pk_bf16_f32 v3, v3, v3
  v_and_b32 v3, 0xffff0000, v3
  v_mul_f32 v3, 0x3db504f3, v3
  v_cvt_pk_bf16_f32 v3, v3, v3
  v_and_b32 v3, 0xffff0000, v3
  v_max_f32 v5, v5, v3
  ds_write_b32 v215, v3 offset:0
  s_waitcnt vmcnt(4)
  buffer_load_dwordx4 v[164:167], v2, s[28:31], s63 offen offset:1024 nt
  v_dot2_f32_bf16 v16, v144, v40, 0
  v_dot2_f32_bf16 v16, v145, v41, v16
  v_dot2_f32_bf16 v16, v146, v42, v16
  v_dot2_f32_bf16 v16, v147, v43, v16
  s_waitcnt vmcnt(4)
  buffer_load_dwordx4 v[168:171], v2, s[28:31], s63 offen offset:2048 nt
  v_dot2_f32_bf16 v17, v148, v40, 0
  v_dot2_f32_bf16 v17, v149, v41, v17
  v_dot2_f32_bf16 v17, v150, v42, v17
  v_dot2_f32_bf16 v17, v151, v43, v17
  s_waitcnt vmcnt(4)
  buffer_load_dwordx4 v[172:175], v2, s[28:31], s63 offen offset:3072 nt
  v_dot2_f32_bf16 v18, v152, v40, 0
  v_dot2_f32_bf16 v18, v153, v41, v18
  v_dot2_f32_bf16 v18, v154, v42, v18
  v_dot2_f32_bf16 v18, v155, v43, v18
  s_waitcnt vmcnt(4)
  buffer_load_dwordx4 v[176:179], v2, s[32:35], s67 offen offset:0 nt
  v_dot2_f32_bf16 v19, v156, v40, 0
  v_dot2_f32_bf16 v19, v157, v41, v19
  v_dot2_f32_bf16 v19, v158, v42, v19
  v_dot2_f32_bf16 v19, v159, v43, v19
  v_add_f32_dpp v3, v16, v16 row_ror:8 row_mask:0xf bank_mask:0x3
  v_add_f32_dpp v4, v17, v17 row_ror:8 row_mask:0xf bank_mask:0x3
  s_nop 0
  v_add_f32_dpp v3, v18, v18 row_ror:8 row_mask:0xf bank_mask:0xc
  v_add_f32_dpp v4, v19, v19 row_ror:8 row_mask:0xf bank_mask:0xc
  s_nop 0
  v_add_f32_dpp v3, v3, v3 row_half_mirror row_mask:0xf bank_mask:0x5
  s_nop 1
  v_add_f32_dpp v3, v4, v4 row_half_mirror row_mask:0xf bank_mask:0xa
  s_nop 1
  v_add_f32_dpp v3, v3, v3 quad_perm:[1,0,3,2] row_mask:0xf bank_mask:0xf
  s_nop 1
  v_add_f32_dpp v3, v3, v3 quad_perm:[2,3,0,1] row_mask:0xf bank_mask:0xf
  v_cvt_pk_bf16_f32 v3, v3, v3
  v_and_b32 v3, 0xffff0000, v3
  v_mul_f32 v3, 0x3db504f3, v3
  v_cvt_pk_bf16_f32 v3, v3, v3
  v_and_b32 v3, 0xffff0000, v3
  v_max_f32 v5, v5, v3
  ds_write_b32 v215, v3 offset:64
  v_add_u32 v215, 128, v215
  s_cmp_eq_u32 s71, 0
  s_cbranch_scc0 L_xk
  s_waitcnt vmcnt(4)
  buffer_load_dwordx4 v[180:183], v2, s[32:35], s67 offen offset:1024 nt
  v_dot2_f32_bf16 v16, v160, v40, 0
  v_dot2_f32_bf16 v16, v161, v41, v16
  v_dot2_f32_bf16 v16, v162, v42, v16
  v_dot2_f32_bf16 v16, v163, v43, v16
  s_waitcnt vmcnt(4)
  buffer_load_dwordx4 v[184:187], v2, s[32:35], s67 offen offset:2048 nt
  v_dot2_f32_bf16 v17, v164, v40, 0
  v_dot2_f32_bf16 v17, v165, v41, v17
  v_dot2_f32_bf16 v17, v166, v42, v17
  v_dot2_f32_bf16 v17, v167, v43, v17
  s_waitcnt vmcnt(4)
  buffer_load_dwordx4 v[188:191], v2, s[32:35], s67 offen offset:3072 nt
  v_dot2_f32_bf16 v18, v168, v40, 0
  v_dot2_f32_bf16 v18, v169, v41, v18
  v_dot2_f32_bf16 v18, v170, v42, v18
  v_dot2_f32_bf16 v18, v171, v43, v18
  s_swappc_b64 s[78:79], s[80:81]
  s_waitcnt vmcnt(4)
  buffer_load_dwordx4 v[128:131], v2, s[28:31], s63 offen offset:0 nt
  v_dot2_f32_bf16 v19, v172, v40, 0
  v_dot2_f32_bf16 v19, v173, v41, v19
  v_dot2_f32_bf16 v19, v174, v42, v19
  v_dot2_f32_bf16 v19, v175, v43, v19
  v_add_f32_dpp v3, v16, v16 row_ror:8 row_mask:0xf bank_mask:0x3
  v_add_f32_dpp v4, v17, v17 row_ror:8 row_mask:0xf bank_mask:0x3
  s_nop 0
  v_add_f32_dpp v3, v18, v18 row_ror:8 row_mask:0xf bank_mask:0xc
  v_add_f32_dpp v4, v19, v19 row_ror:8 row_mask:0xf bank_mask:0xc
  s_nop 0
  v_add_f32_dpp v3, v3, v3 row_half_mirror row_mask:0xf bank_mask:0x5
  s_nop 1
  v_add_f32_dpp v3, v4, v4 row_half_mirror row_mask:0xf bank_mask:0xa
  s_nop 1
  v_add_f32_dpp v3, v3, v3 quad_perm:[1,0,3,2] row_mask:0xf bank_mask:0xf
  s_nop 1
  v_add_f32_dpp v3, v3, v3 quad_perm:[2,3,0,1] row_mask:0xf bank_mask:0xf
  v_cvt_pk_bf16_f32 v3, v3, v3
  v_and_b32 v3, 0xffff0000, v3
  v_mul_f32 v3, 0x3db504f3, v3
  v_cvt_pk_bf16_f32 v3, v3, v3
  v_and_b32 v3, 0xffff0000, v3
  v_max_f32 v5, v5, v3
  ds_write_b32 v215, v3 offset:0
  s_waitcnt vmcnt(4)
  buffer_load_dwordx4 v[132:135], v2, s[28:31], s63 offen offset:1024 nt
  v_dot2_f32_bf16 v16, v176, v40, 0
  v_dot2_f32_bf16 v16, v177, v41, v16
  v_dot2_f32_bf16 v16, v178, v42, v16
  v_dot2_f32_bf16 v16, v179, v43, v16
  s_waitcnt vmcnt(4)
  buffer_load_dwordx4 v[136:139], v2, s[28:31], s63 offen offset:2048 nt
  v_dot2_f32_bf16 v17, v180, v40, 0
  v_dot2_f32_bf16 v17, v181, v41, v17
  v_dot2_f32_bf16 v17, v182, v42, v17
  v_dot2_f32_bf16 v17, v183, v43, v17
  s_waitcnt vmcnt(4)
  buffer_load_dwordx4 v[140:143], v2, s[28:31], s63 offen offset:3072 nt
  v_dot2_f32_bf16 v18, v184, v40, 0
  v_dot2_f32_bf16 v18, v185, v41, v18
  v_dot2_f32_bf16 v18, v186, v42, v18
  v_dot2_f32_bf16 v18, v187, v43, v18
  s_waitcnt vmcnt(4)
  buffer_load_dwordx4 v[144:147], v2, s[32:35], s67 offen offset:0 nt
  v_dot2_f32_bf16 v19, v188, v40, 0
  v_dot2_f32_bf16 v19, v189, v41, v19
  v_dot2_f32_bf16 v19, v190, v42, v19
  v_dot2_f32_bf16 v19, v191, v43, v19
  v_add_f32_dpp v3, v16, v16 row_ror:8 row_mask:0xf bank_mask:0x3
  v_add_f32_dpp v4, v17, v17 row_ror:8 row_mask:0xf bank_mask:0x3
  s_nop 0
  v_add_f32_dpp v3, v18, v18 row_ror:8 row_mask:0xf bank_mask:0xc
  v_add_f32_dpp v4, v19, v19 row_ror:8 row_mask:0xf bank_mask:0xc
  s_nop 0
  v_add_f32_dpp v3, v3, v3 row_half_mirror row_mask:0xf bank_mask:0x5
  s_nop 1
  v_add_f32_dpp v3, v4, v4 row_half_mirror row_mask:0xf bank_mask:0xa
  s_nop 1
  v_add_f32_dpp v3, v3, v3 quad_perm:[1,0,3,2] row_mask:0xf bank_mask:0xf
  s_nop 1
  v_add_f32_dpp v3, v3, v3 quad_perm:[2,3,0,1] row_mask:0xf bank_mask:0xf
  v_cvt_pk_bf16_f32 v3, v3, v3
  v_and_b32 v3, 0xffff0000, v3
  v_mul_f32 v3, 0x3db504f3, v3
  v_cvt_pk_bf16_f32 v3, v3, v3
  v_and_b32 v3, 0xffff0000, v3
  v_max_f32 v5, v5, v3
  ds_write_b32 v215, v3 offset:64
  v_add_u32 v215, 128, v215
L_klc:
  s_sub_u32 s19, s19, 1
  s_cmp_lg_u32 s19, 0
  s_cbranch_scc1 L_kl
  v_max_f32_dpp v5, v5, v5 row_ror:4 row_mask:0xf bank_mask:0xf
  v_mov_b32 v215, v255
  ds_read2_b32 v[56:57], v215 offset0:0 offset1:16
  v_max_f32_dpp v5, v5, v5 row_ror:8 row_mask:0xf bank_mask:0xf
  v_mov_b32 v7, 0
  v_mov_b32 v20, 0
  v_max_f32_dpp v5, v5, v5 row_bcast:15 row_mask:0xa bank_mask:0xf
  v_mov_b32 v21, 0
  v_mov_b32 v22, 0
  v_max_f32_dpp v5, v5, v5 row_bcast:31 row_mask:0xc bank_mask:0xf
  v_mov_b32 v23, 0
  v_readlane_b32 s68, v5, 63
  s_cmp_lt_u32 s77, 2
  s_cselect_b32 s19, 8, 7
  v_mov_b32 v5, s68
  v_mul_f32 v6, s74, v5
  v_sub_f32 v6, 0, v6
L_vl:
  s_waitcnt lgkmcnt(0)
  ds_read2_b32 v[58:59], v215 offset0:32 offset1:48
  v_fma_f32 v4, v56, s74, v6
  v_exp_f32 v4, v4
  s_nop 0
  v_add_f32 v7, v7, v4
  v_cvt_pk_bf16_f32 v4, v4, v4
  s_nop 1
  v_and_b32_dpp v24, v4, v12 row_newbcast:0 row_mask:0xf bank_mask:0xf
  v_and_b32_dpp v25, v4, v13 row_newbcast:0 row_mask:0xf bank_mask:0xf
  v_and_b32_dpp v26, v4, v14 row_newbcast:0 row_mask:0xf bank_mask:0xf
  v_and_b32_dpp v27, v4, v15 row_newbcast:0 row_mask:0xf bank_mask:0xf
  v_and_b32_dpp v28, v4, v12 row_newbcast:4 row_mask:0xf bank_mask:0xf
  v_and_b32_dpp v29, v4, v13 row_newbcast:4 row_mask:0xf bank_mask:0xf
  v_and_b32_dpp v30, v4, v14 row_newbcast:4 row_mask:0xf bank_mask:0xf
  v_and_b32_dpp v31, v4, v15 row_newbcast:4 row_mask:0xf bank_mask:0xf
  s_waitcnt vmcnt(4)
  buffer_load_dwordx4 v[148:151], v2, s[32:35], s67 offen offset:1024 nt
  v_mfma_f32_16x16x32_bf16 v[20:23], v[128:131], v[24:27], v[20:23]
  v_and_b32_dpp v32, v4, v12 row_newbcast:8 row_mask:0xf bank_mask:0xf
  v_and_b32_dpp v33, v4, v13 row_newbcast:8 row_mask:0xf bank_mask:0xf
  v_and_b32_dpp v34, v4, v14 row_newbcast:8 row_mask:0xf bank_mask:0xf
  v_and_b32_dpp v35, v4, v15 row_newbcast:8 row_mask:0xf bank_mask:0xf
  s_waitcnt vmcnt(4)
  buffer_load_dwordx4 v[152:155], v2, s[32:35], s67 offen offset:2048 nt
  v_mfma_f32_16x16x32_bf16 v[20:23], v[132:135], v[28:31], v[20:23]
  v_and_b32_dpp v36, v4, v12 row_newbcast:12 row_mask:0xf bank_mask:0xf
  v_and_b32_dpp v37, v4, v13 row_newbcast:12 row_mask:0xf bank_mask:0xf
  v_and_b32_dpp v38, v4, v14 row_newbcast:12 row_mask:0xf bank_mask:0xf
  v_and_b32_dpp v39, v4, v15 row_newbcast:12 row_mask:0xf bank_mask:0xf
  s_waitcnt vmcnt(4)
  buffer_load_dwordx4 v[156:159], v2, s[32:35], s67 offen offset:3072 nt
  v_mfma_f32_16x16x32_bf16 v[20:23], v[136:139], v[32:35], v[20:23]
  s_swappc_b64 s[78:79], s[80:81]
  s_waitcnt vmcnt(4)
  buffer_load_dwordx4 v[160:163], v2, s[28:31], s63 offen offset:0 nt
  v_mfma_f32_16x16x32_bf16 v[20:23], v[140:143], v[36:39], v[20:23]
  v_fma_f32 v4, v57, s74, v6
  v_exp_f32 v4, v4
  s_nop 0
  v_add_f32 v7, v7, v4
  v_cvt_pk_bf16_f32 v4, v4, v4
  s_nop 1
  v_and_b32_dpp v24, v4, v12 row_newbcast:0 row_mask:0xf bank_mask:0xf
  v_and_b32_dpp v25, v4, v13 row_newbcast:0 row_mask:0xf bank_mask:0xf
  v_and_b32_dpp v26, v4, v14 row_newbcast:0 row_mask:0xf bank_mask:0xf
  v_and_b32_dpp v27, v4, v15 row_newbcast:0 row_mask:0xf bank_mask:0xf
  v_and_b32_dpp v28, v4, v12 row_newbcast:4 row_mask:0xf bank_mask:0xf
  v_and_b32_dpp v29, v4, v13 row_newbcast:4 row_mask:0xf bank_mask:0xf
  v_and_b32_dpp v30, v4, v14 row_newbcast:4 row_mask:0xf bank_mask:0xf
  v_and_b32_dpp v31, v4, v15 row_newbcast:4 row_mask:0xf bank_mask:0xf
  s_waitcnt vmcnt(4)
  buffer_load_dwordx4 v[164:167], v2, s[28:31], s63 offen offset:1024 nt
  v_mfma_f32_16x16x32_bf16 v[20:23], v[144:147], v[24:27], v[20:23]
  v_and_b32_dpp v32, v4, v12 row_newbcast:8 row_mask:0xf bank_mask:0xf
  v_and_b32_dpp v33, v4, v13 row_newbcast:8 row_mask:0xf bank_mask:0xf
  v_and_b32_dpp v34, v4, v14 row_newbcast:8 row_mask:0xf bank_mask:0xf
  v_and_b32_dpp v35, v4, v15 row_newbcast:8 row_mask:0xf bank_mask:0xf
  s_waitcnt vmcnt(4)
  buffer_load_dwordx4 v[168:171], v2, s[28:31], s63 offen offset:2048 nt
  v_mfma_f32_16x16x32_bf16 v[20:23], v[148:151], v[28:31], v[20:23]
  v_and_b32_dpp v36, v4, v12 row_newbcast:12 row_mask:0xf bank_mask:0xf
  v_and_b32_dpp v37, v4, v13 row_newbcast:12 row_mask:0xf bank_mask:0xf
  v_and_b32_dpp v38, v4, v14 row_newbcast:12 row_mask:0xf bank_mask:0xf
  v_and_b32_dpp v39, v4, v15 row_newbcast:12 row_mask:0xf bank_mask:0xf
  s_waitcnt vmcnt(4)
  buffer_load_dwordx4 v[172:175], v2, s[28:31], s63 offen offset:3072 nt
  v_mfma_f32_16x16x32_bf16 v[20:23], v[152:155], v[32:35], v[20:23]
  s_waitcnt vmcnt(4)
  buffer_load_dwordx4 v[176:179], v2, s[32:35], s67 offen offset:0 nt
  v_mfma_f32_16x16x32_bf16 v[20:23], v[156:159], v[36:39], v[20:23]
  s_waitcnt lgkmcnt(0)
  ds_read2_b32 v[56:57], v215 offset0:64 offset1:80
  v_fma_f32 v4, v58, s74, v6
  v_exp_f32 v4, v4
  s_nop 0
  v_add_f32 v7, v7, v4
  v_cvt_pk_bf16_f32 v4, v4, v4
  s_nop 1
  v_and_b32_dpp v24, v4, v12 row_newbcast:0 row_mask:0xf bank_mask:0xf
  v_and_b32_dpp v25, v4, v13 row_newbcast:0 row_mask:0xf bank_mask:0xf
  v_and_b32_dpp v26, v4, v14 row_newbcast:0 row_mask:0xf bank_mask:0xf
  v_and_b32_dpp v27, v4, v15 row_newbcast:0 row_mask:0xf bank_mask:0xf
  v_and_b32_dpp v28, v4, v12 row_newbcast:4 row_mask:0xf bank_mask:0xf
  v_and_b32_dpp v29, v4, v13 row_newbcast:4 row_mask:0xf bank_mask:0xf
  v_and_b32_dpp v30, v4, v14 row_newbcast:4 row_mask:0xf bank_mask:0xf
  v_and_b32_dpp v31, v4, v15 row_newbcast:4 row_mask:0xf bank_mask:0xf
  s_waitcnt vmcnt(4)
  buffer_load_dwordx4 v[180:183], v2, s[32:35], s67 offen offset:1024 nt
  v_mfma_f32_16x16x32_bf16 v[20:23], v[160:163], v[24:27], v[20:23]
  v_and_b32_dpp v32, v4, v12 row_newbcast:8 row_mask:0xf bank_mask:0xf
  v_and_b32_dpp v33, v4, v13 row_newbcast:8 row_mask:0xf bank_mask:0xf
  v_and_b32_dpp v34, v4, v14 row_newbcast:8 row_mask:0xf bank_mask:0xf
  v_and_b32_dpp v35, v4, v15 row_newbcast:8 row_mask:0xf bank_mask:0xf
  s_waitcnt vmcnt(4)
  buffer_load_dwordx4 v[184:187], v2, s[32:35], s67 offen offset:2048 nt
  v_mfma_f32_16x16x32_bf16 v[20:23], v[164:167], v[28:31], v[20:23]
  v_and_b32_dpp v36, v4, v12 row_newbcast:12 row_mask:0xf bank_mask:0xf
  v_and_b32_dpp v37, v4, v13 row_newbcast:12 row_mask:0xf bank_mask:0xf
  v_and_b32_dpp v38, v4, v14 row_newbcast:12 row_mask:0xf bank_mask:0xf
  v_and_b32_dpp v39, v4, v15 row_newbcast:12 row_mask:0xf bank_mask:0xf
  s_waitcnt vmcnt(4)
  buffer_load_dwordx4 v[188:191], v2, s[32:35], s67 offen offset:3072 nt
  v_mfma_f32_16x16x32_bf16 v[20:23], v[168:171], v[32:35], v[20:23]
  s_swappc_b64 s[78:79], s[80:81]
  s_waitcnt vmcnt(4)
  buffer_load_dwordx4 v[128:131], v2, s[28:31], s63 offen offset:0 nt
  v_mfma_f32_16x16x32_bf16 v[20:23], v[172:175], v[36:39], v[20:23]
  v_fma_f32 v4, v59, s74, v6
  v_exp_f32 v4, v4
  s_nop 0
  v_add_f32 v7, v7, v4
  v_cvt_pk_bf16_f32 v4, v4, v4
  s_nop 1
  v_and_b32_dpp v24, v4, v12 row_newbcast:0 row_mask:0xf bank_mask:0xf
  v_and_b32_dpp v25, v4, v13 row_newbcast:0 row_mask:0xf bank_mask:0xf
  v_and_b32_dpp v26, v4, v14 row_newbcast:0 row_mask:0xf bank_mask:0xf
  v_and_b32_dpp v27, v4, v15 row_newbcast:0 row_mask:0xf bank_mask:0xf
  v_and_b32_dpp v28, v4, v12 row_newbcast:4 row_mask:0xf bank_mask:0xf
  v_and_b32_dpp v29, v4, v13 row_newbcast:4 row_mask:0xf bank_mask:0xf
  v_and_b32_dpp v30, v4, v14 row_newbcast:4 row_mask:0xf bank_mask:0xf
  v_and_b32_dpp v31, v4, v15 row_newbcast:4 row_mask:0xf bank_mask:0xf
  s_waitcnt vmcnt(4)
  buffer_load_dwordx4 v[132:135], v2, s[28:31], s63 offen offset:1024 nt
  v_mfma_f32_16x16x32_bf16 v[20:23], v[176:179], v[24:27], v[20:23]
  v_and_b32_dpp v32, v4, v12 row_newbcast:8 row_mask:0xf bank_mask:0xf
  v_and_b32_dpp v33, v4, v13 row_newbcast:8 row_mask:0xf bank_mask:0xf
  v_and_b32_dpp v34, v4, v14 row_newbcast:8 row_mask:0xf bank_mask:0xf
  v_and_b32_dpp v35, v4, v15 row_newbcast:8 row_mask:0xf bank_mask:0xf
  s_waitcnt vmcnt(4)
  buffer_load_dwordx4 v[136:139], v2, s[28:31], s63 offen offset:2048 nt
  v_mfma_f32_16x16x32_bf16 v[20:23], v[180:183], v[28:31], v[20:23]
  v_and_b32_dpp v36, v4, v12 row_newbcast:12 row_mask:0xf bank_mask:0xf
  v_and_b32_dpp v37, v4, v13 row_newbcast:12 row_mask:0xf bank_mask:0xf
  v_and_b32_dpp v38, v4, v14 row_newbcast:12 row_mask:0xf bank_mask:0xf
  v_and_b32_dpp v39, v4, v15 row_newbcast:12 row_mask:0xf bank_mask:0xf
  s_waitcnt vmcnt(4)
  buffer_load_dwordx4 v[140:143], v2, s[28:31], s63 offen offset:3072 nt
  v_mfma_f32_16x16x32_bf16 v[20:23], v[184:187], v[32:35], v[20:23]
  s_waitcnt vmcnt(4)
  buffer_load_dwordx4 v[144:147], v2, s[32:35], s67 offen offset:0 nt
  v_mfma_f32_16x16x32_bf16 v[20:23], v[188:191], v[36:39], v[20:23]
  v_add_u32 v215, 256, v215
  s_sub_u32 s19, s19, 1
  s_cmp_lg_u32 s19, 0
  s_cbranch_scc1 L_vl
  s_cmp_lg_u32 s77, 2
  s_cbranch_scc1 L_loop
  v_mov_b32 v40, v52
  v_mov_b32 v41, v53
  v_mov_b32 v42, v54
  v_mov_b32 v43, v55
  v_mov_b32 v252, v5
  v_mov_b32 v253, v7
  v_mov_b32 v248, v20
  v_mov_b32 v249, v21
  v_mov_b32 v250, v22
  v_mov_b32 v251, v23
  v_mov_b32 v5, 0xff800000
  v_mov_b32 v215, v255
  s_mov_b32 s19, 7
  s_branch L_kl
L_xk:
  ds_read_b128 v[64:67], v9 offset:0
  ds_read_b128 v[68:71], v9 offset:1024
  ds_read_b128 v[72:75], v9 offset:2048
  ds_read_b128 v[76:79], v9 offset:3072
  ds_read_b128 v[80:83], v9 offset:4096
  ds_read_b128 v[84:87], v9 offset:5120
  ds_read_b128 v[88:91], v9 offset:6144
  ds_read_b128 v[92:95], v9 offset:7168
  v_add_u32 v9, 8192, v9
  s_sub_u32 s71, s71, 1
  s_waitcnt vmcnt(4)
  buffer_load_dwordx4 v[180:183], v2, s[32:35], s67 offen offset:1024 nt
  v_dot2_f32_bf16 v16, v160, v40, 0
  v_dot2_f32_bf16 v16, v161, v41, v16
  v_dot2_f32_bf16 v16, v162, v42, v16
  v_dot2_f32_bf16 v16, v163, v43, v16
  s_waitcnt lgkmcnt(0)
  v_dot2_f32_bf16 v104, v64, v40, 0
  v_dot2_f32_bf16 v104, v65, v41, v104
  v_dot2_f32_bf16 v104, v66, v42, v104
  v_dot2_f32_bf16 v104, v67, v43, v104
  v_dot2_f32_bf16 v105, v68, v40, 0
  v_dot2_f32_bf16 v105, v69, v41, v105
  v_dot2_f32_bf16 v105, v70, v42, v105
  v_dot2_f32_bf16 v105, v71, v43, v105
  s_waitcnt vmcnt(4)
  buffer_load_dwordx4 v[184:187], v2, s[32:35], s67 offen offset:2048 nt
  v_dot2_f32_bf16 v17, v164, v40, 0
  v_dot2_f32_bf16 v17, v165, v41, v17
  v_dot2_f32_bf16 v17, v166, v42, v17
  v_dot2_f32_bf16 v17, v167, v43, v17
  v_dot2_f32_bf16 v106, v72, v40, 0
  v_dot2_f32_bf16 v106, v73, v41, v106
  v_dot2_f32_bf16 v106, v74, v42, v106
  v_dot2_f32_bf16 v106, v75, v43, v106
  v_dot2_f32_bf16 v107, v76, v40, 0
  v_dot2_f32_bf16 v107, v77, v41, v107
  v_dot2_f32_bf16 v107, v78, v42, v107
  v_dot2_f32_bf16 v107, v79, v43, v107
  s_waitcnt vmcnt(4)
  buffer_load_dwordx4 v[188:191], v2, s[32:35], s67 offen offset:3072 nt
  v_dot2_f32_bf16 v18, v168, v40, 0
  v_dot2_f32_bf16 v18, v169, v41, v18
  v_dot2_f32_bf16 v18, v170, v42, v18
  v_dot2_f32_bf16 v18, v171, v43, v18
  v_add_f32_dpp v3, v104, v104 row_ror:8 row_mask:0xf bank_mask:0x3
  v_add_f32_dpp v4, v105, v105 row_ror:8 row_mask:0xf bank_mask:0x3
  s_nop 0
  v_add_f32_dpp v3, v106, v106 row_ror:8 row_mask:0xf bank_mask:0xc
  v_add_f32_dpp v4, v107, v107 row_ror:8 row_mask:0xf bank_mask:0xc
  s_nop 0
  v_add_f32_dpp v3, v3, v3 row_half_mirror row_mask:0xf bank_mask:0x5
  s_nop 1
  v_add_f32_dpp v3, v4, v4 row_half_mirror row_mask:0xf bank_mask:0xa
  s_nop 1
  v_add_f32_dpp v3, v3, v3 quad_perm:[1,0,3,2] row_mask:0xf bank_mask:0xf
  s_nop 1
  v_add_f32_dpp v3, v3, v3 quad_perm:[2,3,0,1] row_mask:0xf bank_mask:0xf
  v_cvt_pk_bf16_f32 v3, v3, v3
  v_and_b32 v3, 0xffff0000, v3
  v_mul_f32 v3, 0x3db504f3, v3
  v_cvt_pk_bf16_f32 v3, v3, v3
  v_and_b32 v3, 0xffff0000, v3
  v_max_f32 v5, v5, v3
  ds_write_b32 v254, v3 offset:0
  s_swappc_b64 s[78:79], s[80:81]
  s_waitcnt vmcnt(4)
  buffer_load_dwordx4 v[128:131], v2, s[28:31], s63 offen offset:0 nt
  v_dot2_f32_bf16 v19, v172, v40, 0
  v_dot2_f32_bf16 v19, v173, v41, v19
  v_dot2_f32_bf16 v19, v174, v42, v19
  v_dot2_f32_bf16 v19, v175, v43, v19
  v_add_f32_dpp v3, v16, v16 row_ror:8 row_mask:0xf bank_mask:0x3
  v_add_f32_dpp v4, v17, v17 row_ror:8 row_mask:0xf bank_mask:0x3
  s_nop 0
  v_add_f32_dpp v3, v18, v18 row_ror:8 row_mask:0xf bank_mask:0xc
  v_add_f32_dpp v4, v19, v19 row_ror:8 row_mask:0xf bank_mask:0xc
  s_nop 0
  v_add_f32_dpp v3, v3, v3 row_half_mirror row_mask:0xf bank_mask:0x5
  s_nop 1
  v_add_f32_dpp v3, v4, v4 row_half_mirror row_mask:0xf bank_mask:0xa
  s_nop 1
  v_add_f32_dpp v3, v3, v3 quad_perm:[1,0,3,2] row_mask:0xf bank_mask:0xf
  s_nop 1
  v_add_f32_dpp v3, v3, v3 quad_perm:[2,3,0,1] row_mask:0xf bank_mask:0xf
  v_cvt_pk_bf16_f32 v3, v3, v3
  v_and_b32 v3, 0xffff0000, v3
  v_mul_f32 v3, 0x3db504f3, v3
  v_cvt_pk_bf16_f32 v3, v3, v3
  v_and_b32 v3, 0xffff0000, v3
  v_max_f32 v5, v5, v3
  ds_write_b32 v215, v3 offset:0
  s_waitcnt vmcnt(4)
  buffer_load_dwordx4 v[132:135], v2, s[28:31], s63 offen offset:1024 nt
  v_dot2_f32_bf16 v16, v176, v40, 0
  v_dot2_f32_bf16 v16, v177, v41, v16
  v_dot2_f32_bf16 v16, v178, v42, v16
  v_dot2_f32_bf16 v16, v179, v43, v16
  v_dot2_f32_bf16 v104, v80, v40, 0
  v_dot2_f32_bf16 v104, v81, v41, v104
  v_dot2_f32_bf16 v104, v82, v42, v104
  v_dot2_f32_bf16 v104, v83, v43, v104
  v_dot2_f32_bf16 v105, v84, v40, 0
  v_dot2_f32_bf16 v105, v85, v41, v105
  v_dot2_f32_bf16 v105, v86, v42, v105
  v_dot2_f32_bf16 v105, v87, v43, v105
  s_waitcnt vmcnt(4)
  buffer_load_dwordx4 v[136:139], v2, s[28:31], s63 offen offset:2048 nt
  v_dot2_f32_bf16 v17, v180, v40, 0
  v_dot2_f32_bf16 v17, v181, v41, v17
  v_dot2_f32_bf16 v17, v182, v42, v17
  v_dot2_f32_bf16 v17, v183, v43, v17
  v_dot2_f32_bf16 v106, v88, v40, 0
  v_dot2_f32_bf16 v106, v89, v41, v106
  v_dot2_f32_bf16 v106, v90, v42, v106
  v_dot2_f32_bf16 v106, v91, v43, v106
  v_dot2_f32_bf16 v107, v92, v40, 0
  v_dot2_f32_bf16 v107, v93, v41, v107
  v_dot2_f32_bf16 v107, v94, v42, v107
  v_dot2_f32_bf16 v107, v95, v43, v107
  s_waitcnt vmcnt(4)
  buffer_load_dwordx4 v[140:143], v2, s[28:31], s63 offen offset:3072 nt
  v_dot2_f32_bf16 v18, v184, v40, 0
  v_dot2_f32_bf16 v18, v185, v41, v18
  v_dot2_f32_bf16 v18, v186, v42, v18
  v_dot2_f32_bf16 v18, v187, v43, v18
  v_add_f32_dpp v3, v104, v104 row_ror:8 row_mask:0xf bank_mask:0x3
  v_add_f32_dpp v4, v105, v105 row_ror:8 row_mask:0xf bank_mask:0x3
  s_nop 0
  v_add_f32_dpp v3, v106, v106 row_ror:8 row_mask:0xf bank_mask:0xc
  v_add_f32_dpp v4, v107, v107 row_ror:8 row_mask:0xf bank_mask:0xc
  s_nop 0
  v_add_f32_dpp v3, v3, v3 row_half_mirror row_mask:0xf bank_mask:0x5
  s_nop 1
  v_add_f32_dpp v3, v4, v4 row_half_mirror row_mask:0xf bank_mask:0xa
  s_nop 1
  v_add_f32_dpp v3, v3, v3 quad_perm:[1,0,3,2] row_mask:0xf bank_mask:0xf
  s_nop 1
  v_add_f32_dpp v3, v3, v3 quad_perm:[2,3,0,1] row_mask:0xf bank_mask:0xf
  v_cvt_pk_bf16_f32 v3, v3, v3
  v_and_b32 v3, 0xffff0000, v3
  v_mul_f32 v3, 0x3db504f3, v3
  v_cvt_pk_bf16_f32 v3, v3, v3
  v_and_b32 v3, 0xffff0000, v3
  v_max_f32 v5, v5, v3
  ds_write_b32 v254, v3 offset:64
  s_waitcnt vmcnt(4)
  buffer_load_dwordx4 v[144:147], v2, s[32:35], s67 offen offset:0 nt
  v_dot2_f32_bf16 v19, v188, v40, 0
  v_dot2_f32_bf16 v19, v189, v41, v19
  v_dot2_f32_bf16 v19, v190, v42, v19
  v_dot2_f32_bf16 v19, v191, v43, v19
  v_add_f32_dpp v3, v16, v16 row_ror:8 row_mask:0xf bank_mask:0x3
  v_add_f32_dpp v4, v17, v17 row_ror:8 row_mask:0xf bank_mask:0x3
  s_nop 0
  v_add_f32_dpp v3, v18, v18 row_ror:8 row_mask:0xf bank_mask:0xc
  v_add_f32_dpp v4, v19, v19 row_ror:8 row_mask:0xf bank_mask:0xc
  s_nop 0
  v_add_f32_dpp v3, v3, v3 row_half_mirror row_mask:0xf bank_mask:0x5
  s_nop 1
  v_add_f32_dpp v3, v4, v4 row_half_mirror row_mask:0xf bank_mask:0xa
  s_nop 1
  v_add_f32_dpp v3, v3, v3 quad_perm:[1,0,3,2] row_mask:0xf bank_mask:0xf
  s_nop 1
  v_add_f32_dpp v3, v3, v3 quad_perm:[2,3,0,1] row_mask:0xf bank_mask:0xf
  v_cvt_pk_bf16_f32 v3, v3, v3
  v_and_b32 v3, 0xffff0000, v3
  v_mul_f32 v3, 0x3db504f3, v3
  v_cvt_pk_bf16_f32 v3, v3, v3
  v_and_b32 v3, 0xffff0000, v3
  v_max_f32 v5, v5, v3
  ds_write_b32 v215, v3 offset:64
  v_add_u32 v254, 128, v254
  v_add_u32 v215, 128, v215
  s_branch L_klc
L_loop:
  s_cmp_eq_u32 s75, 0
  s_cbranch_scc1 L_done
  s_waitcnt vmcnt(4)
  buffer_load_dwordx4 v[148:151], v2, s[32:35], s67 offen offset:1024 nt
  v_dot2_f32_bf16 v16, v128, v40, 0
  v_dot2_f32_bf16 v16, v129, v41, v16
  v_dot2_f32_bf16 v16, v130, v42, v16
  v_dot2_f32_bf16 v16, v131, v43, v16
  s_waitcnt vmcnt(4)
  buffer_load_dwordx4 v[152:155], v2, s[32:35], s67 offen offset:2048 nt
  v_dot2_f32_bf16 v17, v132, v40, 0
  v_dot2_f32_bf16 v17, v133, v41, v17
  v_dot2_f32_bf16 v17, v134, v42, v17
  v_dot2_f32_bf16 v17, v135, v43, v17
  s_waitcnt vmcnt(4)
  buffer_load_dwordx4 v[156:159], v2, s[32:35], s67 offen offset:3072 nt
  v_dot2_f32_bf16 v18, v136, v40, 0
  v_dot2_f32_bf16 v18, v137, v41, v18
  v_dot2_f32_bf16 v18, v138, v42, v18
  v_dot2_f32_bf16 v18, v139, v43, v18
  s_swappc_b64 s[78:79], s[80:81]
  s_waitcnt vmcnt(4)
  buffer_load_dwordx4 v[160:163], v2, s[28:31], s63 offen offset:0 nt
  v_dot2_f32_bf16 v19, v140, v40, 0
  v_dot2_f32_bf16 v19, v141, v41, v19
  v_dot2_f32_bf16 v19, v142, v42, v19
  v_dot2_f32_bf16 v19, v143, v43, v19
  v_add_f32_dpp v3, v16, v16 row_ror:8 row_mask:0xf bank_mask:0x3
  v_add_f32_dpp v4, v17, v17 row_ror:8 row_mask:0xf bank_mask:0x3
  s_nop 0
  v_add_f32_dpp v3, v18, v18 row_ror:8 row_mask:0xf bank_mask:0xc
  v_add_f32_dpp v4, v19, v19 row_ror:8 row_mask:0xf bank_mask:0xc
  s_nop 0
  v_add_f32_dpp v3, v3, v3 row_half_mirror row_mask:0xf bank_mask:0x5
  s_nop 1
  v_add_f32_dpp v3, v4, v4 row_half_mirror row_mask:0xf bank_mask:0xa
  s_nop 1
  v_add_f32_dpp v3, v3, v3 quad_perm:[1,0,3,2] row_mask:0xf bank_mask:0xf
  s_nop 1
  v_add_f32_dpp v3, v3, v3 quad_perm:[2,3,0,1] row_mask:0xf bank_mask:0xf
  v_cvt_pk_bf16_f32 v3, v3, v3
  v_and_b32 v3, 0xffff0000, v3
  v_mul_f32 v3, 0x3db504f3, v3
  v_cvt_pk_bf16_f32 v3, v3, v3
  v_and_b32 v3, 0xffff0000, v3
  s_waitcnt vmcnt(4)
  buffer_load_dwordx4 v[164:167], v2, s[28:31], s63 offen offset:1024 nt
  v_cmp_gt_f32 vcc, v3, v5
  s_cbranch_vccnz L_resc0
L_cont0:
  v_fma_f32 v4, v3, s74, v6
  v_exp_f32 v4, v4
  s_nop 0
  v_add_f32 v7, v7, v4
  v_cvt_pk_bf16_f32 v4, v4, v4
  s_nop 1
  v_and_b32_dpp v24, v4, v12 row_newbcast:0 row_mask:0xf bank_mask:0xf
  v_and_b32_dpp v25, v4, v13 row_newbcast:0 row_mask:0xf bank_mask:0xf
  v_and_b32_dpp v26, v4, v14 row_newbcast:0 row_mask:0xf bank_mask:0xf
  v_and_b32_dpp v27, v4, v15 row_newbcast:0 row_mask:0xf bank_mask:0xf
  v_and_b32_dpp v28, v4, v12 row_newbcast:4 row_mask:0xf bank_mask:0xf
  v_and_b32_dpp v29, v4, v13 row_newbcast:4 row_mask:0xf bank_mask:0xf
  v_and_b32_dpp v30, v4, v14 row_newbcast:4 row_mask:0xf bank_mask:0xf
  v_and_b32_dpp v31, v4, v15 row_newbcast:4 row_mask:0xf bank_mask:0xf
  v_mfma_f32_16x16x32_bf16 v[20:23], v[144:147], v[24:27], v[20:23]
  v_and_b32_dpp v32, v4, v12 row_newbcast:8 row_mask:0xf bank_mask:0xf
  v_and_b32_dpp v33, v4, v13 row_newbcast:8 row_mask:0xf bank_mask:0xf
  v_and_b32_dpp v34, v4, v14 row_newbcast:8 row_mask:0xf bank_mask:0xf
  v_and_b32_dpp v35, v4, v15 row_newbcast:8 row_mask:0xf bank_mask:0xf
  s_waitcnt vmcnt(4)
  buffer_load_dwordx4 v[168:171], v2, s[28:31], s63 offen offset:2048 nt
  v_mfma_f32_16x16x32_bf16 v[20:23], v[148:151], v[28:31], v[20:23]
  v_and_b32_dpp v36, v4, v12 row_newbcast:12 row_mask:0xf bank_mask:0xf
  v_and_b32_dpp v37, v4, v13 row_newbcast:12 row_mask:0xf bank_mask:0xf
  v_and_b32_dpp v38, v4, v14 row_newbcast:12 row_mask:0xf bank_mask:0xf
  v_and_b32_dpp v39, v4, v15 row_newbcast:12 row_mask:0xf bank_mask:0xf
  s_waitcnt vmcnt(4)
  buffer_load_dwordx4 v[172:175], v2, s[28:31], s63 offen offset:3072 nt
  v_mfma_f32_16x16x32_bf16 v[20:23], v[152:155], v[32:35], v[20:23]
  s_waitcnt vmcnt(4)
  buffer_load_dwordx4 v[176:179], v2, s[32:35], s67 offen offset:0 nt
  v_mfma_f32_16x16x32_bf16 v[20:23], v[156:159], v[36:39], v[20:23]
  s_cmp_eq_u32 s75, 0
  s_cbranch_scc1 L_done
  s_waitcnt vmcnt(4)
  buffer_load_dwordx4 v[180:183], v2, s[32:35], s67 offen offset:1024 nt
  v_dot2_f32_bf16 v16, v160, v40, 0
  v_dot2_f32_bf16 v16, v161, v41, v16
  v_dot2_f32_bf16 v16, v162, v42, v16
  v_dot2_f32_bf16 v16, v163, v43, v16
  s_waitcnt vmcnt(4)
  buffer_load_dwordx4 v[184:187], v2, s[32:35], s67 offen offset:2048 nt
  v_dot2_f32_bf16 v17, v164, v40, 0
  v_dot2_f32_bf16 v17, v165, v41, v17
  v_dot2_f32_bf16 v17, v166, v42, v17
  v_dot2_f32_bf16 v17, v167, v43, v17
  s_waitcnt vmcnt(4)
  buffer_load_dwordx4 v[188:191], v2, s[32:35], s67 offen offset:3072 nt
  v_dot2_f32_bf16 v18, v168, v40, 0
  v_dot2_f32_bf16 v18, v169, v41, v18
  v_dot2_f32_bf16 v18, v170, v42, v18
  v_dot2_f32_bf16 v18, v171, v43, v18
  s_swappc_b64 s[78:79], s[80:81]
  s_waitcnt vmcnt(4)
  buffer_load_dwordx4 v[128:131], v2, s[28:31], s63 offen offset:0 nt
  v_dot2_f32_bf16 v19, v172, v40, 0
  v_dot2_f32_bf16 v19, v173, v41, v19
  v_dot2_f32_bf16 v19, v174, v42, v19
  v_dot2_f32_bf16 v19, v175, v43, v19
  v_add_f32_dpp v3, v16, v16 row_ror:8 row_mask:0xf bank_mask:0x3
  v_add_f32_dpp v4, v17, v17 row_ror:8 row_mask:0xf bank_mask:0x3
  s_nop 0
  v_add_f32_dpp v3, v18, v18 row_ror:8 row_mask:0xf bank_mask:0xc
  v_add_f32_dpp v4, v19, v19 row_ror:8 row_mask:0xf bank_mask:0xc
  s_nop 0
  v_add_f32_dpp v3, v3, v3 row_half_mirror row_mask:0xf bank_mask:0x5
  s_nop 1
  v_add_f32_dpp v3, v4, v4 row_half_mirror row_mask:0xf bank_mask:0xa
  s_nop 1
  v_add_f32_dpp v3, v3, v3 quad_perm:[1,0,3,2] row_mask:0xf bank_mask:0xf
  s_nop 1
  v_add_f32_dpp v3, v3, v3 quad_perm:[2,3,0,1] row_mask:0xf bank_mask:0xf
  v_cvt_pk_bf16_f32 v3, v3, v3
  v_and_b32 v3, 0xffff0000, v3
  v_mul_f32 v3, 0x3db504f3, v3
  v_cvt_pk_bf16_f32 v3, v3, v3
  v_and_b32 v3, 0xffff0000, v3
  s_waitcnt vmcnt(4)
  buffer_load_dwordx4 v[132:135], v2, s[28:31], s63 offen offset:1024 nt
  v_cmp_gt_f32 vcc, v3, v5
  s_cbranch_vccnz L_resc1
L_cont1:
  v_fma_f32 v4, v3, s74, v6
  v_exp_f32 v4, v4
  s_nop 0
  v_add_f32 v7, v7, v4
  v_cvt_pk_bf16_f32 v4, v4, v4
  s_nop 1
  v_and_b32_dpp v24, v4, v12 row_newbcast:0 row_mask:0xf bank_mask:0xf
  v_and_b32_dpp v25, v4, v13 row_newbcast:0 row_mask:0xf bank_mask:0xf
  v_and_b32_dpp v26, v4, v14 row_newbcast:0 row_mask:0xf bank_mask:0xf
  v_and_b32_dpp v27, v4, v15 row_newbcast:0 row_mask:0xf bank_mask:0xf
  v_and_b32_dpp v28, v4, v12 row_newbcast:4 row_mask:0xf bank_mask:0xf
  v_and_b32_dpp v29, v4, v13 row_newbcast:4 row_mask:0xf bank_mask:0xf
  v_and_b32_dpp v30, v4, v14 row_newbcast:4 row_mask:0xf bank_mask:0xf
  v_and_b32_dpp v31, v4, v15 row_newbcast:4 row_mask:0xf bank_mask:0xf
  v_mfma_f32_16x16x32_bf16 v[20:23], v[176:179], v[24:27], v[20:23]
  v_and_b32_dpp v32, v4, v12 row_newbcast:8 row_mask:0xf bank_mask:0xf
  v_and_b32_dpp v33, v4, v13 row_newbcast:8 row_mask:0xf bank_mask:0xf
  v_and_b32_dpp v34, v4, v14 row_newbcast:8 row_mask:0xf bank_mask:0xf
  v_and_b32_dpp v35, v4, v15 row_newbcast:8 row_mask:0xf bank_mask:0xf
  s_waitcnt vmcnt(4)
  buffer_load_dwordx4 v[136:139], v2, s[28:31], s63 offen offset:2048 nt
  v_mfma_f32_16x16x32_bf16 v[20:23], v[180:183], v[28:31], v[20:23]
  v_and_b32_dpp v36, v4, v12 row_newbcast:12 row_mask:0xf bank_mask:0xf
  v_and_b32_dpp v37, v4, v13 row_newbcast:12 row_mask:0xf bank_mask:0xf
  v_and_b32_dpp v38, v4, v14 row_newbcast:12 row_mask:0xf bank_mask:0xf
  v_and_b32_dpp v39, v4, v15 row_newbcast:12 row_mask:0xf bank_mask:0xf
  s_waitcnt vmcnt(4)
  buffer_load_dwordx4 v[140:143], v2, s[28:31], s63 offen offset:3072 nt
  v_mfma_f32_16x16x32_bf16 v[20:23], v[184:187], v[32:35], v[20:23]
  s_waitcnt vmcnt(4)
  buffer_load_dwordx4 v[144:147], v2, s[32:35], s67 offen offset:0 nt
  v_mfma_f32_16x16x32_bf16 v[20:23], v[188:191], v[36:39], v[20:23]
  s_branch L_loop
L_done:
  buffer_load_dwordx4 a[0:3], v213, s[36:39], s16 offen offset:0 nt
  buffer_load_dwordx4 a[4:7], v213, s[36:39], s16 offen offset:256 nt
  buffer_load_dwordx4 a[8:11], v213, s[36:39], s16 offen offset:512 nt
  buffer_load_dwordx4 a[12:15], v213, s[36:39], s16 offen offset:768 nt
  buffer_load_dwordx4 a[16:19], v213, s[36:39], s16 offen offset:1024 nt
  buffer_load_dwordx4 a[20:23], v213, s[36:39], s17 offen offset:0 nt
  buffer_load_dwordx4 a[24:27], v213, s[36:39], s17 offen offset:256 nt
  buffer_load_dwordx4 a[28:31], v213, s[36:39], s17 offen offset:512 nt
  buffer_load_dwordx4 a[32:35], v213, s[36:39], s17 offen offset:768 nt
  buffer_load_dwordx4 a[36:39], v213, s[36:39], s17 offen offset:1024 nt
  v_add_f32_dpp v7, v7, v7 row_ror:4 row_mask:0xf bank_mask:0xf
  v_add_f32_dpp v253, v253, v253 row_ror:4 row_mask:0xf bank_mask:0xf
  s_lshl_b32 s68, s3, 9
  v_add_f32_dpp v7, v7, v7 row_ror:8 row_mask:0xf bank_mask:0xf
  v_add_f32_dpp v253, v253, v253 row_ror:8 row_mask:0xf bank_mask:0xf
  v_add_u32 v48, s68, v46
  v_add_f32_dpp v7, v7, v7 row_bcast:15 row_mask:0xa bank_mask:0xf
  v_add_f32_dpp v253, v253, v253 row_bcast:15 row_mask:0xa bank_mask:0xf
  s_lshl_b32 s69, s3, 4
  v_add_f32_dpp v7, v7, v7 row_bcast:31 row_mask:0xc bank_mask:0xf
  v_add_f32_dpp v253, v253, v253 row_bcast:31 row_mask:0xc bank_mask:0xf
  v_mov_b32 v49, s69
  v_mov_b32 v6, v5
  s_mov_b32 exec_lo, 0x00ff00ff
  s_mov_b32 exec_hi, 0x00ff00ff
  ds_write_b128 v48, v[248:251] offset:0
  ds_write_b128 v48, v[20:23] offset:2048
  s_mov_b32 exec_lo, 0
  s_mov_b32 exec_hi, 0x80000000
  ds_write_b64 v49, v[252:253] offset:6400
  ds_write_b64 v49, v[6:7] offset:6464
  s_mov_b64 exec, -1
  v_lshrrev_b32 v50, 5, v1
  v_and_b32 v51, 3, v1
  v_lshl_add_u32 v51, v50, 2, v51
  v_bfe_u32 v49, v1, 2, 3
  v_lshlrev_b32 v49, 4, v49
  v_lshl_add_u32 v49, v51, 9, v49
  s_lshl_b32 s69, s3, 7
  v_add_u32 v49, s69, v49
  v_lshlrev_b32 v48, 4, v51
  s_mov_b32 s71, 0
  s_waitcnt lgkmcnt(0)
  s_barrier
  ds_read_b64 v[108:109], v48 offset:6400
  ds_read_b128 v[104:107], v49 offset:0
  s_waitcnt lgkmcnt(1)
  v_max_f32_dpp v110, v108, v108 quad_perm:[1,0,3,2] row_mask:0xf bank_mask:0xf
  s_nop 1
  v_max_f32_dpp v110, v110, v110 quad_perm:[2,3,0,1] row_mask:0xf bank_mask:0xf
  v_and_b32 v110, -2, v110
  v_sub_f32 v108, v108, v110
  v_mul_f32 v108, s74, v108
  v_exp_f32 v108, v108
  s_waitcnt lgkmcnt(0)
  v_mul_f32 v109, v108, v109
  v_mul_f32 v104, v108, v104
  v_mul_f32 v105, v108, v105
  v_mul_f32 v106, v108, v106
  v_mul_f32 v107, v108, v107
  v_add_f32_dpp v109, v109, v109 quad_perm:[1,0,3,2] row_mask:0xf bank_mask:0xf
  v_add_f32_dpp v104, v104, v104 quad_perm:[1,0,3,2] row_mask:0xf bank_mask:0xf
  v_add_f32_dpp v105, v105, v105 quad_perm:[1,0,3,2] row_mask:0xf bank_mask:0xf
  v_add_f32_dpp v106, v106, v106 quad_perm:[1,0,3,2] row_mask:0xf bank_mask:0xf
  v_add_f32_dpp v107, v107, v107 quad_perm:[1,0,3,2] row_mask:0xf bank_mask:0xf
  v_add_f32_dpp v109, v109, v109 quad_perm:[2,3,0,1] row_mask:0xf bank_mask:0xf
  v_add_f32_dpp v104, v104, v104 quad_perm:[2,3,0,1] row_mask:0xf bank_mask:0xf
  v_add_f32_dpp v105, v105, v105 quad_perm:[2,3,0,1] row_mask:0xf bank_mask:0xf
  v_add_f32_dpp v106, v106, v106 quad_perm:[2,3,0,1] row_mask:0xf bank_mask:0xf
  v_add_f32_dpp v107, v107, v107 quad_perm:[2,3,0,1] row_mask:0xf bank_mask:0xf
  s_mov_b32 exec_lo, 2
  s_mov_b32 exec_hi, 2
  v_mov_b32 v104, v110
  v_mov_b32 v105, v109
  s_mov_b32 exec_lo, 0x11111113
  s_mov_b32 exec_hi, 0x11111113
  v_bfi_b32 v104, 1, v200, v104
  v_bfi_b32 v105, 1, v201, v105
  v_bfi_b32 v106, 1, v202, v106
  v_bfi_b32 v107, 1, v203, v107
  buffer_store_dwordx4 v[104:107], v210, s[44:47], s8 offen sc1
  s_mov_b64 exec, -1
L_p1:
  buffer_load_dwordx2 v[112:113], v208, s[44:47], s11 offen sc1
  buffer_load_dwordx2 v[114:115], v209, s[44:47], s10 offen offset:1024 sc1
  s_waitcnt vmcnt(0)
  v_xor_b32 v116, v112, v196
  v_bitop3_b32 v116, v113, v197, v116 bitop3:0x28
  v_bitop3_b32 v116, v114, v198, v116 bitop3:0x28
  v_bitop3_b32 v116, v115, v199, v116 bitop3:0x28
  v_and_b32 v116, 1, v116
  v_cmp_eq_u32 vcc, 0, v116
  s_and_b64 exec, exec, vcc
  s_cbranch_execz L_p1ok
  s_add_u32 s71, s71, 1
  s_and_b32 s68, s71, 63
  s_cbranch_scc0 L_repub
L_p1b:
  s_branch L_p1
L_p1ok:
  s_mov_b64 exec, -1
  v_and_b32 v114, -2, v114
  v_and_b32 v112, -2, v112
  v_and_b32 v113, -2, v113
  v_and_b32 v115, -2, v115
  v_max_f32_dpp v116, v114, v114 quad_perm:[1,0,3,2] row_mask:0xf bank_mask:0xf
  s_nop 1
  v_max_f32_dpp v116, v116, v116 quad_perm:[2,3,0,1] row_mask:0xf bank_mask:0xf
  s_nop 1
  v_max_f32_dpp v116, v116, v116 row_half_mirror row_mask:0xf bank_mask:0xf
  v_sub_f32 v114, v114, v116
  v_mul_f32 v114, s74, v114
  v_exp_f32 v114, v114
  s_nop 0
  v_mul_f32 v115, v114, v115
  v_mul_f32 v112, v114, v112
  v_mul_f32 v113, v114, v113
  v_add_f32_dpp v115, v115, v115 quad_perm:[1,0,3,2] row_mask:0xf bank_mask:0xf
  v_add_f32_dpp v112, v112, v112 quad_perm:[1,0,3,2] row_mask:0xf bank_mask:0xf
  v_add_f32_dpp v113, v113, v113 quad_perm:[1,0,3,2] row_mask:0xf bank_mask:0xf
  v_add_f32_dpp v115, v115, v115 quad_perm:[2,3,0,1] row_mask:0xf bank_mask:0xf
  v_add_f32_dpp v112, v112, v112 quad_perm:[2,3,0,1] row_mask:0xf bank_mask:0xf
  v_add_f32_dpp v113, v113, v113 quad_perm:[2,3,0,1] row_mask:0xf bank_mask:0xf
  v_add_f32_dpp v115, v115, v115 row_half_mirror row_mask:0xf bank_mask:0xf
  v_add_f32_dpp v112, v112, v112 row_half_mirror row_mask:0xf bank_mask:0xf
  v_add_f32_dpp v113, v113, v113 row_half_mirror row_mask:0xf bank_mask:0xf
  v_rcp_f32 v115, v115
  s_nop 0
  v_mul_f32 v112, v112, v115
  v_mul_f32 v113, v113, v115
  v_cvt_pk_bf16_f32 v112, v112, v112
  v_cvt_pk_bf16_f32 v113, v113, v113
  v_and_b32 v24, v112, v12
  v_and_b32 v25, v112, v13
  v_and_b32 v26, v112, v14
  v_and_b32 v27, v112, v15
  v_and_b32 v28, v113, v12
  v_and_b32 v29, v113, v13
  v_and_b32 v30, v113, v14
  v_and_b32 v31, v113, v15
  v_mfma_f32_16x16x32_bf16 v[64:67], a[0:3], v[24:27], 0
  v_mfma_f32_16x16x32_bf16 v[68:71], a[4:7], v[24:27], 0
  v_mfma_f32_16x16x32_bf16 v[72:75], a[8:11], v[24:27], 0
  v_mfma_f32_16x16x32_bf16 v[76:79], a[12:15], v[24:27], 0
  v_mfma_f32_16x16x32_bf16 v[80:83], a[16:19], v[24:27], 0
  v_mfma_f32_16x16x32_bf16 v[64:67], a[20:23], v[28:31], v[64:67]
  v_mfma_f32_16x16x32_bf16 v[68:71], a[24:27], v[28:31], v[68:71]
  v_mfma_f32_16x16x32_bf16 v[72:75], a[28:31], v[28:31], v[72:75]
  v_mfma_f32_16x16x32_bf16 v[76:79], a[32:35], v[28:31], v[76:79]
  v_mfma_f32_16x16x32_bf16 v[80:83], a[36:39], v[28:31], v[80:83]
  s_mul_i32 s69, s3, 2560
  v_add_u32 v48, s69, v46
  s_mov_b32 exec_lo, 0x00ff00ff
  s_mov_b32 exec_hi, 0x00ff00ff
  ds_write_b128 v48, v[64:67] offset:6656
  ds_write_b128 v48, v[68:71] offset:7168
  ds_write_b128 v48, v[72:75] offset:7680
  ds_write_b128 v48, v[76:79] offset:8192
  ds_write_b128 v48, v[80:83] offset:8704
  s_mov_b64 exec, -1
  s_cmp_lg_u32 s60, 0xfffff
  s_cbranch_scc1 L_cnt0
L_cntok:
  s_waitcnt lgkmcnt(0)
  s_barrier
  s_cmp_ge_u32 s3, 3
  s_cbranch_scc1 L_pubdone
  ds_read_b128 v[64:67], v212 offset:6656
  ds_read_b128 v[68:71], v212 offset:9216
  ds_read_b128 v[72:75], v212 offset:11776
  ds_read_b128 v[76:79], v212 offset:14336
  s_waitcnt lgkmcnt(2)
  v_add_f32 v64, v64, v68
  v_add_f32 v65, v65, v69
  v_add_f32 v66, v66, v70
  v_add_f32 v67, v67, v71
  s_waitcnt lgkmcnt(0)
  v_add_f32 v72, v72, v76
  v_add_f32 v73, v73, v77
  v_add_f32 v74, v74, v78
  v_add_f32 v75, v75, v79
  v_add_f32 v64, v64, v72
  v_add_f32 v65, v65, v73
  v_add_f32 v66, v66, v74
  v_add_f32 v67, v67, v75
  v_bfi_b32 v64, 1, v204, v64
  v_bfi_b32 v65, 1, v205, v65
  v_bfi_b32 v66, 1, v206, v66
  v_bfi_b32 v67, 1, v207, v67
  buffer_store_dwordx4 v[64:67], v211, s[44:47], s9 offen sc1
L_pubdone:
  s_cmp_ge_u32 s84, 20
  s_cbranch_scc1 L_fin
L_p2:
  buffer_load_dwordx4 v[128:131], v212, s[44:47], s48 offen sc1
  buffer_load_dwordx4 v[132:135], v212, s[44:47], s49 offen sc1
  buffer_load_dwordx4 v[136:139], v212, s[44:47], s50 offen sc1
  buffer_load_dwordx4 v[140:143], v212, s[44:47], s51 offen sc1
  buffer_load_dwordx4 v[144:147], v212, s[44:47], s52 offen sc1
  buffer_load_dwordx4 v[148:151], v212, s[44:47], s53 offen sc1
  buffer_load_dwordx4 v[152:155], v212, s[44:47], s54 offen sc1
  buffer_load_dwordx4 v[156:159], v212, s[44:47], s55 offen sc1
  s_waitcnt vmcnt(7)
  v_xor_b32 v160, v128, v216
  v_bitop3_b32 v160, v129, v217, v160 bitop3:0x28
  v_bitop3_b32 v160, v130, v218, v160 bitop3:0x28
  v_bitop3_b32 v160, v131, v219, v160 bitop3:0x28
  v_and_b32 v128, -2, v128
  v_and_b32 v129, -2, v129
  v_and_b32 v130, -2, v130
  v_and_b32 v131, -2, v131
  s_waitcnt vmcnt(6)
  v_bitop3_b32 v160, v132, v220, v160 bitop3:0x28
  v_bitop3_b32 v160, v133, v221, v160 bitop3:0x28
  v_bitop3_b32 v160, v134, v222, v160 bitop3:0x28
  v_bitop3_b32 v160, v135, v223, v160 bitop3:0x28
  v_and_b32 v132, -2, v132
  v_and_b32 v133, -2, v133
  v_and_b32 v134, -2, v134
  v_and_b32 v135, -2, v135
  s_waitcnt vmcnt(5)
  v_bitop3_b32 v160, v136, v224, v160 bitop3:0x28
  v_bitop3_b32 v160, v137, v225, v160 bitop3:0x28
  v_bitop3_b32 v160, v138, v226, v160 bitop3:0x28
  v_bitop3_b32 v160, v139, v227, v160 bitop3:0x28
  v_and_b32 v136, -2, v136
  v_and_b32 v137, -2, v137
  v_and_b32 v138, -2, v138
  v_and_b32 v139, -2, v139
  s_waitcnt vmcnt(4)
  v_bitop3_b32 v160, v140, v228, v160 bitop3:0x28
  v_bitop3_b32 v160, v141, v229, v160 bitop3:0x28
  v_bitop3_b32 v160, v142, v230, v160 bitop3:0x28
  v_bitop3_b32 v160, v143, v231, v160 bitop3:0x28
  v_and_b32 v140, -2, v140
  v_and_b32 v141, -2, v141
  v_and_b32 v142, -2, v142
  v_and_b32 v143, -2, v143
  s_waitcnt vmcnt(3)
  v_bitop3_b32 v160, v144, v232, v160 bitop3:0x28
  v_bitop3_b32 v160, v145, v233, v160 bitop3:0x28
  v_bitop3_b32 v160, v146, v234, v160 bitop3:0x28
  v_bitop3_b32 v160, v147, v235, v160 bitop3:0x28
  v_and_b32 v144, -2, v144
  v_and_b32 v145, -2, v145
  v_and_b32 v146, -2, v146
  v_and_b32 v147, -2, v147
  s_waitcnt vmcnt(2)
  v_bitop3_b32 v160, v148, v236, v160 bitop3:0x28
  v_bitop3_b32 v160, v149, v237, v160 bitop3:0x28
  v_bitop3_b32 v160, v150, v238, v160 bitop3:0x28
  v_bitop3_b32 v160, v151, v239, v160 bitop3:0x28
  v_and_b32 v148, -2, v148
  v_and_b32 v149, -2, v149
  v_and_b32 v150, -2, v150
  v_and_b32 v151, -2, v151
  s_waitcnt vmcnt(1)
  v_bitop3_b32 v160, v152, v240, v160 bitop3:0x28
  v_bitop3_b32 v160, v153, v241, v160 bitop3:0x28
  v_bitop3_b32 v160, v154, v242, v160 bitop3:0x28
  v_bitop3_b32 v160, v155, v243, v160 bitop3:0x28
  v_and_b32 v152, -2, v152
  v_and_b32 v153, -2, v153
  v_and_b32 v154, -2, v154
  v_and_b32 v155, -2, v155
  s_waitcnt vmcnt(0)
  v_bitop3_b32 v160, v156, v244, v160 bitop3:0x28
  v_bitop3_b32 v160, v157, v245, v160 bitop3:0x28
  v_bitop3_b32 v160, v158, v246, v160 bitop3:0x28
  v_bitop3_b32 v160, v159, v247, v160 bitop3:0x28
  v_and_b32 v156, -2, v156
  v_and_b32 v157, -2, v157
  v_and_b32 v158, -2, v158
  v_and_b32 v159, -2, v159
  v_and_b32 v160, 1, v160
  v_cmp_eq_u32 vcc, 0, v160
  s_and_b64 exec, exec, vcc
  s_cbranch_execz L_p2ok
  s_branch L_p2
L_p2ok:
  s_mov_b64 exec, -1
  v_add_f32 v128, v128, v132
  v_add_f32 v129, v129, v133
  v_add_f32 v130, v130, v134
  v_add_f32 v131, v131, v135
  v_add_f32 v136, v136, v140
  v_add_f32 v137, v137, v141
  v_add_f32 v138, v138, v142
  v_add_f32 v139, v139, v143
  v_add_f32 v128, v128, v136
  v_add_f32 v129, v129, v137
  v_add_f32 v130, v130, v138
  v_add_f32 v131, v131, v139
  v_add_f32 v144, v144, v148
  v_add_f32 v145, v145, v149
  v_add_f32 v146, v146, v150
  v_add_f32 v147, v147, v151
  v_add_f32 v152, v152, v156
  v_add_f32 v153, v153, v157
  v_add_f32 v154, v154, v158
  v_add_f32 v155, v155, v159
  v_add_f32 v144, v144, v152
  v_add_f32 v145, v145, v153
  v_add_f32 v146, v146, v154
  v_add_f32 v147, v147, v155
  v_lshrrev_b32 v48, 4, v0
  v_and_b32 v51, 7, v0
  v_add_f32_dpp v128, v128, v128 row_ror:8 row_mask:0xf bank_mask:0xf
  v_add_f32_dpp v129, v129, v129 row_ror:8 row_mask:0xf bank_mask:0xf
  v_add_f32_dpp v130, v130, v130 row_ror:8 row_mask:0xf bank_mask:0xf
  v_add_f32_dpp v131, v131, v131 row_ror:8 row_mask:0xf bank_mask:0xf
  v_add_f32_dpp v144, v144, v144 row_ror:8 row_mask:0xf bank_mask:0xf
  v_add_f32_dpp v145, v145, v145 row_ror:8 row_mask:0xf bank_mask:0xf
  v_add_f32_dpp v146, v146, v146 row_ror:8 row_mask:0xf bank_mask:0xf
  v_add_f32_dpp v147, v147, v147 row_ror:8 row_mask:0xf bank_mask:0xf
  v_lshlrev_b32 v48, 7, v48
  v_lshl_add_u32 v48, v51, 4, v48
  s_mov_b32 exec_lo, 0x00ff00ff
  s_mov_b32 exec_hi, 0x00ff00ff
  ds_write_b128 v48, v[128:131]
  ds_write_b128 v48, v[144:147] offset:2048
  s_mov_b64 exec, -1
  v_lshrrev_b32 v48, 5, v1
  v_lshlrev_b32 v48, 11, v48
  v_and_b32 v50, 31, v1
  v_lshl_add_u32 v48, v50, 2, v48
  v_mov_b32 v3, 0
  v_add_u32 v51, 1024, v48
  s_waitcnt lgkmcnt(0)
  s_barrier
  s_cmp_lg_u32 s3, 0
  s_cbranch_scc1 L_fin
  ds_read2_b32 v[128:129], v48 offset0:0 offset1:32
  ds_read2_b32 v[130:131], v48 offset0:64 offset1:96
  ds_read2_b32 v[132:133], v48 offset0:128 offset1:160
  ds_read2_b32 v[134:135], v48 offset0:192 offset1:224
  ds_read2_b32 v[136:137], v51 offset0:0 offset1:32
  ds_read2_b32 v[138:139], v51 offset0:64 offset1:96
  ds_read2_b32 v[140:141], v51 offset0:128 offset1:160
  ds_read2_b32 v[142:143], v51 offset0:192 offset1:224
  ds_read_b64 v[16:17], v3 offset:6144
  v_and_b32 v49, 3, v50
  v_lshlrev_b32 v49, 4, v49
  v_lshrrev_b32 v50, 2, v50
  v_lshl_add_u32 v49, v50, 1, v49
  s_lshl_b32 s68, s84, 6
  s_mov_b64 s[40:41], s[22:23]
  s_waitcnt lgkmcnt(0)
  v_add_f32 v128, v128, v136
  v_add_f32 v129, v129, v137
  v_add_f32 v130, v130, v138
  v_add_f32 v131, v131, v139
  v_add_f32 v132, v132, v140
  v_add_f32 v133, v133, v141
  v_add_f32 v134, v134, v142
  v_add_f32 v135, v135, v143
  v_add_f32 v128, v128, v132
  v_add_f32 v129, v129, v133
  v_add_f32 v130, v130, v134
  v_add_f32 v131, v131, v135
  v_add_f32 v128, v128, v130
  v_add_f32 v129, v129, v131
  v_add_f32 v128, v128, v129
  v_cvt_pk_bf16_f32 v128, v128, v128
  v_and_b32 v128, 0xffff0000, v128
  v_mov_b32 v129, v128
  s_nop 1
  v_permlane32_swap_b32 v128, v129
  v_mul_f32 v128, v16, v128
  v_mul_f32 v129, v17, v129
  v_cvt_pk_bf16_f32 v128, v128, v129
  v_lshlrev_b32 v129, 16, v128
  v_and_b32 v128, 0xffff0000, v128
  v_add_f32 v128, v128, v129
  v_cvt_pk_bf16_f32 v128, v128, v128
  s_mov_b32 exec_hi, 0
  buffer_store_short v128, v49, s[40:43], s68 offen
  s_mov_b64 exec, -1
L_fin:
  s_endpgm
L_next:
  s_cmp_eq_u32 s77, 4
  s_cbranch_scc1 L_ndyn
  s_sub_u32 s66, s66, 1
  s_cbranch_scc1 L_nsw
L_nst:
  s_lshr_b32 s68, s64, 3
  s_and_b32 s68, s68, 0x1c000
  s_xor_b32 s63, s64, s68
  s_xor_b32 s67, s63, 0x24000
  s_add_u32 s64, s64, 262144
  s_lshl_b32 s68, s66, 2
  s_or_b32 s68, s68, s77
  s_cmp_lg_u32 s68, 3
  s_cbranch_scc1 L_nret
L_nat:
  s_mov_b32 s65, 1
  s_atomic_add s65, s[26:27], s73 glc
L_nret:
  s_setpc_b64 s[78:79]
L_nsw:
  s_add_u32 s77, s77, 1
  s_mov_b32 s64, s18
  s_cmp_eq_u32 s77, 1
  s_cselect_b32 s66, 15, 13
  s_cselect_b64 s[28:29], s[6:7], s[12:13]
  s_cmp_eq_u32 s77, 3
  s_cselect_b64 s[28:29], s[14:15], s[28:29]
  s_cmp_eq_u32 s77, 4
  s_cbranch_scc1 L_ndk
  s_mov_b64 s[32:33], s[28:29]
  s_branch L_nst
L_ndyn:
L_ndk:
  s_waitcnt lgkmcnt(0)
  s_add_u32 s68, s65, s85
  s_cmp_lt_u32 s68, 256
  s_cbranch_scc0 L_ninv
  s_lshl_b32 s63, s68, 14
  s_add_u32 s63, s63, s72
  s_mov_b32 s67, s63
  s_mov_b32 s66, 0
  s_branch L_nat
L_ninv:
  s_mov_b32 s75, 0
  s_mov_b32 s30, 0
  s_mov_b32 s34, 0
  s_load_dword s60, s[24:25], 0
  global_load_dword v63, v[126:127], off
  s_setpc_b64 s[78:79]
L_resc0:
  s_nop 0
  v_max_f32_dpp v8, v3, v3 row_ror:4 row_mask:0xf bank_mask:0xf
  s_nop 1
  v_max_f32_dpp v8, v8, v8 row_ror:8 row_mask:0xf bank_mask:0xf
  s_nop 1
  v_max_f32_dpp v8, v8, v8 row_bcast:15 row_mask:0xa bank_mask:0xf
  s_nop 1
  v_max_f32_dpp v8, v8, v8 row_bcast:31 row_mask:0xc bank_mask:0xf
  s_nop 0
  v_readlane_b32 s69, v8, 63
  s_nop 1
  v_subrev_f32 v8, s69, v5
  v_mul_f32 v8, s74, v8
  v_exp_f32 v8, v8
  v_mov_b32 v5, s69
  v_mul_f32 v6, s74, v5
  v_sub_f32 v6, 0, v6
  v_mul_f32 v7, v7, v8
  v_mul_f32 v20, v20, v8
  v_mul_f32 v21, v21, v8
  v_mul_f32 v22, v22, v8
  v_mul_f32 v23, v23, v8
  s_branch L_cont0
L_resc1:
  s_nop 0
  v_max_f32_dpp v8, v3, v3 row_ror:4 row_mask:0xf bank_mask:0xf
  s_nop 1
  v_max_f32_dpp v8, v8, v8 row_ror:8 row_mask:0xf bank_mask:0xf
  s_nop 1
  v_max_f32_dpp v8, v8, v8 row_bcast:15 row_mask:0xa bank_mask:0xf
  s_nop 1
  v_max_f32_dpp v8, v8, v8 row_bcast:31 row_mask:0xc bank_mask:0xf
  s_nop 0
  v_readlane_b32 s69, v8, 63
  s_nop 1
  v_subrev_f32 v8, s69, v5
  v_mul_f32 v8, s74, v8
  v_exp_f32 v8, v8
  v_mov_b32 v5, s69
  v_mul_f32 v6, s74, v5
  v_sub_f32 v6, 0, v6
  v_mul_f32 v7, v7, v8
  v_mul_f32 v20, v20, v8
  v_mul_f32 v21, v21, v8
  v_mul_f32 v22, v22, v8
  v_mul_f32 v23, v23, v8
  s_branch L_cont1
L_gate:
  s_mov_b32 s68, 0x3f803f80
  v_lshlrev_b32 v120, 16, v104
  v_lshlrev_b32 v121, 16, v112
  v_and_b32 v122, 0xffff0000, v104
  v_and_b32 v123, 0xffff0000, v112
  v_mul_f32 v120, v120, v121
  v_mul_f32 v122, v122, v123
  v_cvt_pk_bf16_f32 v120, v120, v122
  v_dot2_f32_bf16 v124, v120, s68, 0
  v_lshlrev_b32 v120, 16, v105
  v_lshlrev_b32 v121, 16, v113
  v_and_b32 v122, 0xffff0000, v105
  v_and_b32 v123, 0xffff0000, v113
  v_mul_f32 v120, v120, v121
  v_mul_f32 v122, v122, v123
  v_cvt_pk_bf16_f32 v120, v120, v122
  v_dot2_f32_bf16 v124, v120, s68, v124
  v_lshlrev_b32 v120, 16, v106
  v_lshlrev_b32 v121, 16, v114
  v_and_b32 v122, 0xffff0000, v106
  v_and_b32 v123, 0xffff0000, v114
  v_mul_f32 v120, v120, v121
  v_mul_f32 v122, v122, v123
  v_cvt_pk_bf16_f32 v120, v120, v122
  v_dot2_f32_bf16 v124, v120, s68, v124
  v_lshlrev_b32 v120, 16, v107
  v_lshlrev_b32 v121, 16, v115
  v_and_b32 v122, 0xffff0000, v107
  v_and_b32 v123, 0xffff0000, v115
  v_mul_f32 v120, v120, v121
  v_mul_f32 v122, v122, v123
  v_cvt_pk_bf16_f32 v120, v120, v122
  v_dot2_f32_bf16 v124, v120, s68, v124
  v_lshlrev_b32 v120, 16, v108
  v_lshlrev_b32 v121, 16, v116
  v_and_b32 v122, 0xffff0000, v108
  v_and_b32 v123, 0xffff0000, v116
  v_mul_f32 v120, v120, v121
  v_mul_f32 v122, v122, v123
  v_cvt_pk_bf16_f32 v120, v120, v122
  v_dot2_f32_bf16 v124, v120, s68, v124
  s_nop 2
  v_add_f32_dpp v124, v124, v124 quad_perm:[1,0,3,2] row_mask:0xf bank_mask:0xf
  s_nop 1
  v_add_f32_dpp v124, v124, v124 quad_perm:[2,3,0,1] row_mask:0xf bank_mask:0xf
  s_nop 1
  v_add_f32_dpp v124, v124, v124 row_ror:4 row_mask:0xf bank_mask:0xf
  s_nop 1
  v_add_f32_dpp v124, v124, v124 row_ror:8 row_mask:0xf bank_mask:0xf
  s_nop 1
  v_add_f32_dpp v124, v124, v124 row_bcast:15 row_mask:0xa bank_mask:0xf
  s_nop 1
  v_add_f32_dpp v124, v124, v124 row_bcast:31 row_mask:0xc bank_mask:0xf
  s_nop 1
  v_cvt_pk_bf16_f32 v124, v124, v124
  v_and_b32 v124, 0xffff0000, v124
  v_mul_f32 v124, 0xbfb8aa3b, v124
  v_exp_f32 v124, v124
  s_nop 0
  v_add_f32 v124, 1.0, v124
  v_rcp_f32 v124, v124
  s_nop 0
  v_cvt_pk_bf16_f32 v124, v124, v124
  v_and_b32 v124, 0xffff0000, v124
  v_sub_f32 v125, 1.0, v124
  v_cvt_pk_bf16_f32 v125, v125, v125
  v_and_b32 v125, 0xffff0000, v125
  v_mov_b32 v120, 0
  s_mov_b32 exec_lo, 0
  s_mov_b32 exec_hi, 0x80000000
  ds_write_b64 v120, v[124:125] offset:6144
  s_mov_b64 exec, -1
  s_branch L_gret
L_cnt0:
  buffer_load_dword v104, off, s[56:59], 0 sc1
  s_waitcnt vmcnt(0)
  v_cmp_ne_u32 vcc, 0xfffff, v104
  s_cbranch_vccz L_cntok
  s_sleep 8
  s_branch L_cnt0
L_repub:
  s_cmp_lg_u32 s3, s61
  s_cbranch_scc1 L_p1b
  s_mov_b64 s[68:69], exec
  s_cmp_lt_u32 s62, 4
  s_cselect_b32 exec_lo, -1, 0
  s_cselect_b32 exec_hi, 0, -1
  v_add_u32 v16, 1, v192
  v_bfi_b32 v192, 3, v16, v192
  v_add_u32 v17, 1, v193
  v_bfi_b32 v193, 3, v17, v193
  v_add_u32 v18, 1, v194
  v_bfi_b32 v194, 3, v18, v194
  v_add_u32 v19, 1, v195
  v_bfi_b32 v195, 3, v19, v195
  s_andn2_b32 s70, s2, 4
  s_lshl_b32 s70, s70, 9
  buffer_store_dwordx4 v[192:195], v11, s[44:47], s70 offen sc1
  s_mov_b64 exec, s[68:69]
  s_branch L_p1b
L_late:
  s_cmp_lg_u32 s3, s61
  s_cbranch_scc1 L_lret
  s_cmp_lt_u32 s62, 4
  s_cselect_b32 exec_lo, -1, 0
  s_cselect_b32 exec_hi, 0, -1
  v_add_u32 v16, 1, v192
  v_bfi_b32 v192, 3, v16, v192
  v_add_u32 v17, 1, v193
  v_bfi_b32 v193, 3, v17, v193
  v_add_u32 v18, 1, v194
  v_bfi_b32 v194, 3, v18, v194
  v_add_u32 v19, 1, v195
  v_bfi_b32 v195, 3, v19, v195
  buffer_store_dwordx4 v[192:195], v11, s[44:47], s70 offen sc1
  s_mov_b64 exec, -1
  s_branch L_lret
L_qb:
  s_waitcnt vmcnt(4)
  s_mov_b32 s74, 1
L_qchk:
  v_bitop3_b32 v4, v60, v52, 3 bitop3:0x28
  v_cmp_ne_u32 vcc, 0, v4
  s_nop 1
  v_cndmask_b32 v56, v56, v60, vcc
  v_bitop3_b32 v4, v61, v53, 3 bitop3:0x28
  v_cmp_ne_u32 vcc, 0, v4
  s_nop 1
  v_cndmask_b32 v57, v57, v61, vcc
  v_bitop3_b32 v4, v62, v54, 3 bitop3:0x28
  v_cmp_ne_u32 vcc, 0, v4
  s_nop 1
  v_cndmask_b32 v58, v58, v62, vcc
  v_bitop3_b32 v4, v63, v55, 3 bitop3:0x28
  v_cmp_ne_u32 vcc, 0, v4
  s_nop 1
  v_cndmask_b32 v59, v59, v63, vcc
  v_bitop3_b32 v16, v56, v52, 3 bitop3:0x28
  v_bitop3_b32 v17, v57, v53, 3 bitop3:0x28
  v_bitop3_b32 v18, v58, v54, 3 bitop3:0x28
  v_bitop3_b32 v19, v59, v55, 3 bitop3:0x28
  v_min3_u32 v16, v16, v17, v18
  v_min_u32 v16, v16, v19
  v_cmp_eq_u32 vcc, 0, v16
  s_cbranch_vccz L_qok
  s_mov_b32 s74, 17
  s_sleep 2
  buffer_load_dwordx4 v[60:63], v11, s[44:47], s70 offen sc1
  s_waitcnt vmcnt(0)
  s_branch L_qchk
L_qok:
  s_lshl_b32 s69, s3, 9
  v_add_u32 v8, s69, v11
  v_and_b32 v56, -4, v56
  v_and_b32 v57, -4, v57
  v_and_b32 v58, -4, v58
  v_and_b32 v59, -4, v59
  ds_write_b128 v8, v[56:59] offset:2048
  v_mov_b32 v4, s74
  s_mov_b64 exec, 1
  ds_add_u32 v3, v4 offset:6152
  s_mov_b64 exec, -1
  s_branch L_qdone
L_end:
  s_endpgm
.p2align 8
.fill 768, 4, 0xbf800000
.section .rodata,"a"
.p2align 6
.amdhsa_kernel gated_mix__gqa_block_cached__gqa_block_cached__decode_kernel
  .amdhsa_next_free_vgpr 296
  .amdhsa_next_free_sgpr 102
  .amdhsa_accum_offset 256
  .amdhsa_group_segment_fixed_size 0
  .amdhsa_kernarg_size 112
  .amdhsa_user_sgpr_count 2
  .amdhsa_user_sgpr_kernarg_segment_ptr 1
  .amdhsa_system_sgpr_workgroup_id_x 1
  .amdhsa_float_denorm_mode_32 3
.end_amdhsa_kernel
```
